```python
import torch

def _softmax(x, axis=-1):
    return torch.softmax(x, dim=axis)
def _gelu(x):
    return torch.nn.functional.gelu(x, approximate="tanh")
def _silu(x):
    return torch.nn.functional.silu(x)
def _sigmoid(x):
    return torch.sigmoid(x)
def _layernorm(x, axis=-1, eps=1e-5):
    m = x.mean(dim=axis, keepdim=True)
    v = x.var(dim=axis, keepdim=True, unbiased=False)
    return (x - m) / torch.sqrt(v + eps)
def _scatter_add(tgt, idx, src, axis=0):
    return tgt.clone().index_add_(axis, idx, src)
def _segment_sum(src, seg, n):
    out = torch.zeros((n,) + src.shape[1:], dtype=src.dtype)
    return out.index_add_(0, seg, src)
def _pad(x, pw):
    flat = tuple(v for pair in reversed(pw) for v in pair)
    return torch.nn.functional.pad(x, flat)

kernel_name = 'concat_heads__mha_block_cached__gqa_block_cached__near_ridge'

def setup_inputs():

    _w = (lambda a: (lambda t: t.to(torch.bfloat16) if t.is_floating_point() else t)(torch.as_tensor(a)))
    def _A_setup():
        B, Sq, D = 32, 48, 512
        H, Sk, Dh = 32, 48, 128
        return {
            "x": _w((lambda *s: torch.randn(*s, dtype=torch.bfloat16) * 0.8)(B, Sq, D)),
            "k_cache": _w((lambda *s: torch.randn(*s, dtype=torch.bfloat16) * 0.8)(B, H, Sk, Dh)),
            "v_cache": _w((lambda *s: torch.randn(*s, dtype=torch.bfloat16) * 0.05)(B, H, Sk, Dh)),
            "wq": _w((lambda *s: torch.randn(*s, dtype=torch.bfloat16) * 0.8)(D, H * Dh) * (D ** -0.5)),
            "wo": _w((lambda *s: torch.randn(*s, dtype=torch.bfloat16) * 0.05)(H * Dh, D) * ((H * Dh) ** -0.5)),
        }
    _A_in = _A_setup()

    def _B_setup():
        B, Sq, D = 32, 48, 512
        Hq, Hkv, Sk, Dh = 32, 32, 48, 128
        assert Hq % Hkv == 0, (Hq, Hkv)
        return {
            "x": _w((lambda *s: torch.randn(*s, dtype=torch.bfloat16) * 0.8)(B, Sq, D)),
            "k_cache": _w((lambda *s: torch.randn(*s, dtype=torch.bfloat16) * 0.8)(B, Hkv, Sk, Dh)),
            "v_cache": _w((lambda *s: torch.randn(*s, dtype=torch.bfloat16) * 0.05)(B, Hkv, Sk, Dh)),
            "wq": _w((lambda *s: torch.randn(*s, dtype=torch.bfloat16) * 0.8)(D, Hq * Dh) * (D ** -0.5)),
            "wo": _w((lambda *s: torch.randn(*s, dtype=torch.bfloat16) * 0.05)(Hq * Dh, D) * ((Hq * Dh) ** -0.5)),
        }
    _B_in = _B_setup()

    return {
        "A_x": _A_in["x"],
        "A_k_cache": _A_in["k_cache"],
        "A_v_cache": _A_in["v_cache"],
        "A_wq": _A_in["wq"],
        "A_wo": _A_in["wo"],
        "B_x": _B_in["x"],
        "B_k_cache": _B_in["k_cache"],
        "B_v_cache": _B_in["v_cache"],
        "B_wq": _B_in["wq"],
        "B_wo": _B_in["wo"],
    }

def reference(A_x, A_k_cache, A_v_cache, A_wq, A_wo, B_x, B_k_cache, B_v_cache, B_wq, B_wo):
    def _A_ref(x, k_cache, v_cache, wq, wo):
        B, Sq, D = x.shape
        H, Dh = 32, 128
        q = (lambda x, *d: x.permute(*d))((x @ wq).reshape(B, Sq, H, Dh), 0, 2, 1, 3)
        scores = torch.einsum("bhqd,bhkd->bhqk", q, k_cache) * (Dh ** -0.5)
        p = _softmax(scores, axis=-1)
        o = torch.einsum("bhqk,bhkd->bhqd", p, v_cache)
        return (lambda x, *d: x.permute(*d))(o, 0, 2, 1, 3).reshape(B, Sq, H * Dh) @ wo

    def _B_ref(x, k_cache, v_cache, wq, wo):
        B, Sq, D = x.shape
        Hq, Dh = 32, 128
        Hkv = k_cache.shape[1]
        rep = Hq // Hkv
        q = (lambda x, *d: x.permute(*d))((x @ wq).reshape(B, Sq, Hq, Dh), 0, 2, 1, 3)
        k = (lambda x, n, axis: torch.repeat_interleave(x, n, dim=axis))(k_cache, rep, axis=1)
        v = (lambda x, n, axis: torch.repeat_interleave(x, n, dim=axis))(v_cache, rep, axis=1)
        scores = torch.einsum("bhqd,bhkd->bhqk", q, k) * (Dh ** -0.5)
        p = _softmax(scores, axis=-1)
        o = torch.einsum("bhqk,bhkd->bhqd", p, v)
        return (lambda x, *d: x.permute(*d))(o, 0, 2, 1, 3).reshape(B, Sq, Hq * Dh) @ wo

    a = _A_ref(A_x, A_k_cache, A_v_cache, A_wq, A_wo)
    b = _B_ref(B_x, B_k_cache, B_v_cache, B_wq, B_wo)
    return torch.concatenate([a, b], axis=-1)
```

```asm
; @launch kernel=concat_heads__mha_block_cached__gqa_block_cached__near_ridge_kernel grid=(256,1,1) block=(256,1,1) lds=163840
; @launch kernel=head_reduce_kernel grid=(768,1,1) block=(256,1,1) lds=0
.amdgcn_target "amdgcn-amd-amdhsa--gfx950"
.macro mf a,b,c,d
v_mfma_f32_16x16x32_bf16 \a, \b, \c, \d
.endm
.macro pm a,b,c,d
v_perm_b32 \a, \b, \c, \d
.endm
.macro ar a,b
v_accvgpr_read_b32 \a, \b
.endm
.macro cv a,b,c
v_cvt_pk_bf16_f32 \a, \b, \c
.endm
.text
.globl concat_heads__mha_block_cached__gqa_block_cached__near_ridge_kernel
.p2align 8
.type concat_heads__mha_block_cached__gqa_block_cached__near_ridge_kernel,@function
concat_heads__mha_block_cached__gqa_block_cached__near_ridge_kernel:
s_cmp_lt_u32 s2, 256
s_cbranch_scc1 L_go
s_endpgm
L_go:
s_and_b32 s3, s2, 7
s_lshr_b32 s4, s2, 3
s_lshr_b32 s5, s3, 2
s_mul_i32 s6, s5, 40
s_add_u32 s6, s0, s6
s_addc_u32 s7, s1, 0
s_load_dwordx2 s[8:9], s[6:7], 0
s_load_dwordx2 s[20:21], s[6:7], 8
s_load_dwordx2 s[24:25], s[6:7], 16
s_load_dwordx2 s[12:13], s[6:7], 24
s_load_dwordx2 s[16:17], s[6:7], 32
s_load_dwordx2 s[28:29], s[0:1], 96
v_lshrrev_b32 v15, 6, v0
v_and_b32 v0, 63, v0
v_readfirstlane_b32 s53, v15
s_and_b32 s3, s3, 3
s_lshl_b32 s3, s3, 1
s_and_b32 s57, s4, 1
s_or_b32 s3, s3, s57
s_lshr_b32 s4, s4, 1
s_mov_b32 s36, 8192
s_mov_b32 s37, 16384
s_mov_b32 s38, 24576
s_mov_b32 s39, 32768
s_mov_b32 s40, 40960
s_mov_b32 s41, 49152
s_mov_b32 s42, 57344
s_mov_b32 s43, 4096
s_mov_b32 s44, 24576
s_mov_b32 s45, 28672
s_mov_b32 s46, 32768
s_mov_b32 s48, 65536
s_mov_b32 s49, 81920
s_mov_b32 s50, 0x05040100
s_mov_b32 s51, 0x07060302
s_mov_b32 s52, 0x3e0293ee
s_lshl_b32 s54, s53, 10
s_mul_i32 s56, s53, 12288
s_add_u32 s55, s56, 98304
s_lshl_b32 s58, s53, 8
v_and_b32 v16, 15, v0
v_lshrrev_b32 v17, 4, v0
v_lshlrev_b32 v18, 4, v16
v_lshl_add_u32 v1, v17, 18, v18
v_lshl_add_u32 v2, v17, 15, v18
v_lshl_add_u32 v6, v17, 10, v18
v_lshl_add_u32 v7, v17, 12, v18
v_xor_b32 v19, v16, v17
v_lshlrev_b32 v19, 4, v19
v_lshl_add_u32 v4, v17, 8, v19
v_xor_b32 v5, 0x80, v4
s_lshr_b32 s57, s53, 1
s_lshl_b32 s57, s57, 7
s_lshl_b32 s59, s53, 12
v_xor_b32 v19, s57, v19
v_lshl_add_u32 v19, v17, 10, v19
v_add_u32 v3, s59, v19
v_lshlrev_b32 v19, 2, v17
v_and_b32 v20, 11, v16
v_xor_b32 v19, v19, v20
v_lshlrev_b32 v19, 4, v19
v_lshl_add_u32 v8, v16, 8, v19
s_add_u32 s57, s4, 0
s_and_b32 s57, s57, 3
s_lshl_b32 s32, s57, 20
s_lshr_b32 s57, s4, 1
s_add_u32 s57, s57, 0
s_and_b32 s57, s57, 3
s_lshl_b32 s90, s57, 11
s_mul_i32 s96, s57, 3072
s_add_u32 s57, s4, 1
s_and_b32 s57, s57, 3
s_lshl_b32 s33, s57, 20
s_lshr_b32 s57, s4, 1
s_add_u32 s57, s57, 1
s_and_b32 s57, s57, 3
s_lshl_b32 s91, s57, 11
s_mul_i32 s97, s57, 3072
s_add_u32 s57, s4, 2
s_and_b32 s57, s57, 3
s_lshl_b32 s34, s57, 20
s_lshr_b32 s57, s4, 1
s_add_u32 s57, s57, 2
s_and_b32 s57, s57, 3
s_lshl_b32 s92, s57, 11
s_mul_i32 s98, s57, 3072
s_add_u32 s57, s4, 3
s_and_b32 s57, s57, 3
s_lshl_b32 s35, s57, 20
s_lshr_b32 s57, s4, 1
s_add_u32 s57, s57, 3
s_and_b32 s57, s57, 3
s_lshl_b32 s93, s57, 11
s_mul_i32 s99, s57, 3072
s_add_u32 s57, s4, 0
s_and_b32 s57, s57, 1
s_lshl_b32 s88, s57, 17
s_mul_i32 s94, s57, 24576
s_add_u32 s57, s4, 1
s_and_b32 s57, s57, 1
s_lshl_b32 s89, s57, 17
s_mul_i32 s95, s57, 24576
s_lshr_b32 s57, s4, 2
s_add_u32 s57, s57, 3
s_and_b32 s57, s57, 3
s_lshl_b32 s87, s57, 16
s_lshl_b32 s57, s57, 4
v_xor_b32 v11, s57, v8
s_lshr_b32 s57, s4, 2
s_add_u32 s57, s57, 2
s_and_b32 s57, s57, 3
s_lshl_b32 s86, s57, 16
s_lshl_b32 s57, s57, 4
v_xor_b32 v10, s57, v8
s_lshr_b32 s57, s4, 2
s_add_u32 s57, s57, 1
s_and_b32 s57, s57, 3
s_lshl_b32 s85, s57, 16
s_lshl_b32 s57, s57, 4
v_xor_b32 v9, s57, v8
s_lshr_b32 s57, s4, 2
s_add_u32 s57, s57, 0
s_and_b32 s57, s57, 3
s_lshl_b32 s84, s57, 16
s_lshl_b32 s57, s57, 4
v_xor_b32 v8, s57, v8
v_lshlrev_b32 v19, 4, v0
v_mov_b32 v12, v19
v_add_u32 v13, 0xc000, v19
v_add_u32 v14, s56, v19
v_mov_b32 v0, v1
v_mov_b32 v15, v2
s_waitcnt lgkmcnt(0)
s_mul_i32 s57, s4, 98304
s_add_u32 s8, s8, s57
s_addc_u32 s9, s9, 0
s_and_b32 s9, s9, 0xffff
s_mov_b32 s10, 98304
s_mov_b32 s11, 0x20000
s_lshl_b32 s57, s3, 10
s_add_u32 s57, s57, s58
s_add_u32 s12, s12, s57
s_addc_u32 s13, s13, 0
s_and_b32 s13, s13, 0xffff
s_sub_u32 s14, 0x400000, s57
s_mov_b32 s15, 0x20000
s_lshl_b32 s57, s3, 19
s_add_u32 s57, s57, s58
s_add_u32 s16, s16, s57
s_addc_u32 s17, s17, 0
s_and_b32 s17, s17, 0xffff
s_sub_u32 s18, 0x80000, s58
s_mov_b32 s19, 0x20000
s_lshl_b32 s57, s4, 6
s_lshl_b32 s59, s3, 2
s_add_u32 s57, s57, s59
s_and_b32 s59, s53, 1
s_lshl_b32 s59, s59, 5
s_add_u32 s57, s57, s59
s_lshr_b32 s59, s53, 1
s_add_u32 s57, s57, s59
s_mul_i32 s57, s57, 12288
s_add_u32 s20, s20, s57
s_addc_u32 s21, s21, 0
s_and_b32 s21, s21, 0xffff
s_mov_b32 s22, 36864
s_mov_b32 s23, 0x20000
s_add_u32 s24, s24, s57
s_addc_u32 s25, s25, 0
s_and_b32 s25, s25, 0xffff
s_mov_b32 s26, 36864
s_mov_b32 s27, 0x20000
s_lshl_b32 s57, s5, 4
s_add_u32 s57, s57, s4
s_lshl_b32 s57, s57, 3
s_add_u32 s57, s57, s3
s_mul_i32 s57, s57, 98304
s_add_u32 s57, s57, s58
s_add_u32 s28, s28, s57
s_addc_u32 s29, s29, 0
s_and_b32 s29, s29, 0xffff
s_sub_u32 s30, 98304, s58
s_mov_b32 s31, 0x20000
L_g0:
s_add_u32 m0, s54, 0
s_lshr_b32 s47, s32, 12
s_add_u32 s47, s47, 0
buffer_load_dwordx4 v3, s[8:11], s47 offen lds
s_add_u32 m0, s54, 4096
s_lshr_b32 s47, s32, 12
s_add_u32 s47, s47, 16384
buffer_load_dwordx4 v3, s[8:11], s47 offen lds
s_add_u32 m0, s54, 8192
s_lshr_b32 s47, s32, 12
s_add_u32 s47, s47, 32768
buffer_load_dwordx4 v3, s[8:11], s47 offen lds
s_add_u32 m0, s54, 12288
s_lshr_b32 s47, s32, 12
s_add_u32 s47, s47, 49152
buffer_load_dwordx4 v3, s[8:11], s47 offen lds
s_add_u32 m0, s54, 16384
s_lshr_b32 s47, s32, 12
s_add_u32 s47, s47, 65536
buffer_load_dwordx4 v3, s[8:11], s47 offen lds
s_add_u32 m0, s54, 20480
s_lshr_b32 s47, s32, 12
s_add_u32 s47, s47, 81920
buffer_load_dwordx4 v3, s[8:11], s47 offen lds
s_add_u32 s100, s32, s84
v_add_u32 v1, s100, v0
buffer_load_dwordx4 v[32:35], v1, s[12:15], 0 offen
buffer_load_dwordx4 v[36:39], v1, s[12:15], s36 offen
buffer_load_dwordx4 v[40:43], v1, s[12:15], s37 offen
buffer_load_dwordx4 v[44:47], v1, s[12:15], s38 offen
buffer_load_dwordx4 v[48:51], v1, s[12:15], s39 offen
buffer_load_dwordx4 v[52:55], v1, s[12:15], s40 offen
buffer_load_dwordx4 v[56:59], v1, s[12:15], s41 offen
buffer_load_dwordx4 v[60:63], v1, s[12:15], s42 offen
s_getpc_b64 s[100:101]
L_pc0:
s_lshr_b32 s57, s2, 3
s_lshl_b32 s57, s57, 2
s_add_u32 s57, s57, s53
s_mul_i32 s57, s57, 384
v_lshlrev_b32 v210, 3, v12
v_add_u32 v210, s57, v210
v_min_u32 v210, L_end0-L_pc0, v210
v_mov_b32 v211, s101
v_add_co_u32 v210, vcc, s100, v210
s_nop 1
v_addc_co_u32 v211, vcc, 0, v211, vcc
s_mov_b64 exec, 7
global_load_dword v212, v[210:211], off
s_mov_b64 exec, -1
s_add_u32 s100, s32, s85
v_add_u32 v1, s100, v0
buffer_load_dwordx4 v[64:67], v1, s[12:15], 0 offen
buffer_load_dwordx4 v[68:71], v1, s[12:15], s36 offen
buffer_load_dwordx4 v[72:75], v1, s[12:15], s37 offen
buffer_load_dwordx4 v[76:79], v1, s[12:15], s38 offen
buffer_load_dwordx4 v[80:83], v1, s[12:15], s39 offen
buffer_load_dwordx4 v[84:87], v1, s[12:15], s40 offen
buffer_load_dwordx4 v[88:91], v1, s[12:15], s41 offen
buffer_load_dwordx4 v[92:95], v1, s[12:15], s42 offen
s_waitcnt vmcnt(17)
s_barrier
ds_read_b128 a[192:195], v8 offset:0
ds_read_b128 a[196:199], v8 offset:4096
ds_read_b128 a[200:203], v8 offset:8192
ds_read_b128 a[204:207], v8 offset:12288
ds_read_b128 a[208:211], v8 offset:16384
ds_read_b128 a[212:215], v8 offset:20480
s_waitcnt vmcnt(15)
pm v16,v36,v32,s50
s_waitcnt vmcnt(13)
pm v17,v44,v40,s50
s_waitcnt vmcnt(11)
pm v18,v52,v48,s50
s_waitcnt vmcnt(9)
pm v19,v60,v56,s50
pm v20,v36,v32,s51
pm v21,v44,v40,s51
pm v22,v52,v48,s51
pm v23,v60,v56,s51
s_waitcnt lgkmcnt(5)
mf a[0:3],v[16:19],a[192:195],0
pm v24,v37,v33,s50
s_add_u32 s100, s32, s86
s_waitcnt lgkmcnt(4)
mf a[32:35],v[16:19],a[196:199],0
v_add_u32 v1, s100, v0
s_waitcnt lgkmcnt(3)
mf a[64:67],v[16:19],a[200:203],0
buffer_load_dwordx4 v[96:99], v1, s[12:15], 0 offen
pm v25,v45,v41,s50
s_waitcnt lgkmcnt(2)
mf a[96:99],v[16:19],a[204:207],0
ds_read_b128 a[216:219], v9 offset:0
s_waitcnt lgkmcnt(2)
mf a[128:131],v[16:19],a[208:211],0
pm v26,v53,v49,s50
s_waitcnt lgkmcnt(1)
mf a[160:163],v[16:19],a[212:215],0
pm v27,v61,v57,s50
buffer_load_dwordx4 v[100:103], v1, s[12:15], s36 offen
mf a[4:7],v[20:23],a[192:195],0
pm v28,v37,v33,s51
mf a[36:39],v[20:23],a[196:199],0
pm v29,v45,v41,s51
mf a[68:71],v[20:23],a[200:203],0
ds_read_b128 a[220:223], v9 offset:4096
pm v30,v53,v49,s51
mf a[100:103],v[20:23],a[204:207],0
buffer_load_dwordx4 v[104:107], v1, s[12:15], s37 offen
mf a[132:135],v[20:23],a[208:211],0
pm v31,v61,v57,s51
mf a[164:167],v[20:23],a[212:215],0
mf a[8:11],v[24:27],a[192:195],0
pm v16,v38,v34,s50
buffer_load_dwordx4 v[108:111], v1, s[12:15], s38 offen
mf a[40:43],v[24:27],a[196:199],0
pm v17,v46,v42,s50
mf a[72:75],v[24:27],a[200:203],0
ds_read_b128 a[224:227], v9 offset:8192
mf a[104:107],v[24:27],a[204:207],0
pm v18,v54,v50,s50
mf a[136:139],v[24:27],a[208:211],0
pm v19,v62,v58,s50
mf a[168:171],v[24:27],a[212:215],0
buffer_load_dwordx4 v[112:115], v1, s[12:15], s39 offen
pm v20,v38,v34,s51
mf a[12:15],v[28:31],a[192:195],0
pm v21,v46,v42,s51
mf a[44:47],v[28:31],a[196:199],0
ds_read_b128 a[228:231], v9 offset:12288
mf a[76:79],v[28:31],a[200:203],0
pm v22,v54,v50,s51
mf a[108:111],v[28:31],a[204:207],0
buffer_load_dwordx4 v[116:119], v1, s[12:15], s40 offen
mf a[140:143],v[28:31],a[208:211],0
pm v23,v62,v58,s51
mf a[172:175],v[28:31],a[212:215],0
mf a[16:19],v[16:19],a[192:195],0
pm v24,v39,v35,s50
buffer_load_dwordx4 v[120:123], v1, s[12:15], s41 offen
mf a[48:51],v[16:19],a[196:199],0
pm v25,v47,v43,s50
mf a[80:83],v[16:19],a[200:203],0
ds_read_b128 a[232:235], v9 offset:16384
pm v26,v55,v51,s50
mf a[112:115],v[16:19],a[204:207],0
pm v27,v63,v59,s50
mf a[144:147],v[16:19],a[208:211],0
buffer_load_dwordx4 v[124:127], v1, s[12:15], s42 offen
mf a[176:179],v[16:19],a[212:215],0
pm v28,v39,v35,s51
pm v29,v47,v43,s51
mf a[20:23],v[20:23],a[192:195],0
ds_read_b128 a[236:239], v9 offset:20480
mf a[52:55],v[20:23],a[196:199],0
pm v30,v55,v51,s51
mf a[84:87],v[20:23],a[200:203],0
s_add_u32 s100, s32, s87
v_add_u32 v1, s100, v0
mf a[116:119],v[20:23],a[204:207],0
buffer_load_dwordx4 v[128:131], v1, s[12:15], 0 offen
mf a[148:151],v[20:23],a[208:211],0
pm v31,v63,v59,s51
mf a[180:183],v[20:23],a[212:215],0
mf a[24:27],v[24:27],a[192:195],0
s_waitcnt vmcnt(15)
pm v16,v68,v64,s50
mf a[56:59],v[24:27],a[196:199],0
buffer_load_dwordx4 v[132:135], v1, s[12:15], s36 offen
mf a[88:91],v[24:27],a[200:203],0
s_waitcnt vmcnt(14)
pm v17,v76,v72,s50
mf a[120:123],v[24:27],a[204:207],0
s_waitcnt vmcnt(12)
pm v18,v84,v80,s50
mf a[152:155],v[24:27],a[208:211],0
s_waitcnt vmcnt(10)
pm v19,v92,v88,s50
mf a[184:187],v[24:27],a[212:215],0
buffer_load_dwordx4 v[136:139], v1, s[12:15], s37 offen
mf a[28:31],v[28:31],a[192:195],0
pm v20,v68,v64,s51
mf a[60:63],v[28:31],a[196:199],0
pm v21,v76,v72,s51
mf a[92:95],v[28:31],a[200:203],0
pm v22,v84,v80,s51
mf a[124:127],v[28:31],a[204:207],0
buffer_load_dwordx4 v[140:143], v1, s[12:15], s38 offen
mf a[156:159],v[28:31],a[208:211],0
pm v23,v92,v88,s51
mf a[188:191],v[28:31],a[212:215],0
s_waitcnt lgkmcnt(5)
mf a[0:3],v[16:19],a[216:219],a[0:3]
pm v24,v69,v65,s50
buffer_load_dwordx4 v[144:147], v1, s[12:15], s39 offen
s_waitcnt lgkmcnt(4)
mf a[32:35],v[16:19],a[220:223],a[32:35]
pm v25,v77,v73,s50
ds_read_b128 a[192:195], v10 offset:0
s_waitcnt lgkmcnt(4)
mf a[64:67],v[16:19],a[224:227],a[64:67]
pm v26,v85,v81,s50
s_waitcnt lgkmcnt(3)
mf a[96:99],v[16:19],a[228:231],a[96:99]
s_add_u32 m0, s54, 24576
s_lshr_b32 s47, s33, 12
s_waitcnt lgkmcnt(2)
mf a[128:131],v[16:19],a[232:235],a[128:131]
s_add_u32 s47, s47, 0
s_waitcnt lgkmcnt(1)
mf a[160:163],v[16:19],a[236:239],a[160:163]
buffer_load_dwordx4 v3, s[8:11], s47 offen lds
pm v27,v93,v89,s50
mf a[4:7],v[20:23],a[216:219],a[4:7]
pm v28,v69,v65,s51
mf a[36:39],v[20:23],a[220:223],a[36:39]
buffer_load_dwordx4 v[148:151], v1, s[12:15], s40 offen
pm v29,v77,v73,s51
mf a[68:71],v[20:23],a[224:227],a[68:71]
ds_read_b128 a[196:199], v10 offset:4096
mf a[100:103],v[20:23],a[228:231],a[100:103]
pm v30,v85,v81,s51
buffer_load_dwordx4 v[152:155], v1, s[12:15], s41 offen
mf a[132:135],v[20:23],a[232:235],a[132:135]
pm v31,v93,v89,s51
mf a[164:167],v[20:23],a[236:239],a[164:167]
mf a[8:11],v[24:27],a[216:219],a[8:11]
pm v16,v70,v66,s50
buffer_load_dwordx4 v[156:159], v1, s[12:15], s42 offen
pm v17,v78,v74,s50
mf a[40:43],v[24:27],a[220:223],a[40:43]
ds_read_b128 a[200:203], v10 offset:8192
s_add_u32 m0, s54, 28672
mf a[72:75],v[24:27],a[224:227],a[72:75]
s_lshr_b32 s47, s33, 12
s_add_u32 s47, s47, 16384
mf a[104:107],v[24:27],a[228:231],a[104:107]
buffer_load_dwordx4 v3, s[8:11], s47 offen lds
pm v18,v86,v82,s50
mf a[136:139],v[24:27],a[232:235],a[136:139]
pm v19,v94,v90,s50
s_add_u32 m0, s54, 32768
mf a[168:171],v[24:27],a[236:239],a[168:171]
s_lshr_b32 s47, s33, 12
s_add_u32 s47, s47, 32768
mf a[12:15],v[28:31],a[216:219],a[12:15]
buffer_load_dwordx4 v3, s[8:11], s47 offen lds
pm v20,v70,v66,s51
mf a[44:47],v[28:31],a[220:223],a[44:47]
pm v21,v78,v74,s51
s_add_u32 s100, s33, s84
mf a[76:79],v[28:31],a[224:227],a[76:79]
v_add_u32 v1, s100, v0
buffer_load_dwordx4 v[32:35], v1, s[12:15], 0 offen
mf a[108:111],v[28:31],a[228:231],a[108:111]
ds_read_b128 a[204:207], v10 offset:12288
pm v22,v86,v82,s51
mf a[140:143],v[28:31],a[232:235],a[140:143]
buffer_load_dwordx4 v[36:39], v1, s[12:15], s36 offen
pm v23,v94,v90,s51
mf a[172:175],v[28:31],a[236:239],a[172:175]
mf a[16:19],v[16:19],a[216:219],a[16:19]
pm v24,v71,v67,s50
buffer_load_dwordx4 v[40:43], v1, s[12:15], s37 offen
mf a[48:51],v[16:19],a[220:223],a[48:51]
pm v25,v79,v75,s50
ds_read_b128 a[208:211], v10 offset:16384
mf a[80:83],v[16:19],a[224:227],a[80:83]
pm v26,v87,v83,s50
mf a[112:115],v[16:19],a[228:231],a[112:115]
s_add_u32 m0, s54, 36864
s_lshr_b32 s47, s33, 12
mf a[144:147],v[16:19],a[232:235],a[144:147]
s_add_u32 s47, s47, 49152
mf a[176:179],v[16:19],a[236:239],a[176:179]
buffer_load_dwordx4 v3, s[8:11], s47 offen lds
pm v27,v95,v91,s50
mf a[20:23],v[20:23],a[216:219],a[20:23]
pm v28,v71,v67,s51
mf a[52:55],v[20:23],a[220:223],a[52:55]
buffer_load_dwordx4 v[44:47], v1, s[12:15], s38 offen
pm v29,v79,v75,s51
mf a[84:87],v[20:23],a[224:227],a[84:87]
ds_read_b128 a[212:215], v10 offset:20480
mf a[116:119],v[20:23],a[228:231],a[116:119]
pm v30,v87,v83,s51
buffer_load_dwordx4 v[48:51], v1, s[12:15], s39 offen
mf a[148:151],v[20:23],a[232:235],a[148:151]
pm v31,v95,v91,s51
mf a[180:183],v[20:23],a[236:239],a[180:183]
mf a[24:27],v[24:27],a[216:219],a[24:27]
s_waitcnt vmcnt(23)
pm v16,v100,v96,s50
buffer_load_dwordx4 v[52:55], v1, s[12:15], s40 offen
mf a[56:59],v[24:27],a[220:223],a[56:59]
s_waitcnt vmcnt(22)
pm v17,v108,v104,s50
s_add_u32 m0, s54, 40960
mf a[88:91],v[24:27],a[224:227],a[88:91]
s_lshr_b32 s47, s33, 12
s_add_u32 s47, s47, 65536
mf a[120:123],v[24:27],a[228:231],a[120:123]
buffer_load_dwordx4 v3, s[8:11], s47 offen lds
mf a[152:155],v[24:27],a[232:235],a[152:155]
s_waitcnt vmcnt(21)
pm v18,v116,v112,s50
s_waitcnt vmcnt(19)
pm v19,v124,v120,s50
mf a[184:187],v[24:27],a[236:239],a[184:187]
s_add_u32 m0, s54, 45056
s_lshr_b32 s47, s33, 12
mf a[28:31],v[28:31],a[216:219],a[28:31]
s_add_u32 s47, s47, 81920
buffer_load_dwordx4 v3, s[8:11], s47 offen lds
mf a[60:63],v[28:31],a[220:223],a[60:63]
pm v20,v100,v96,s51
mf a[92:95],v[28:31],a[224:227],a[92:95]
pm v21,v108,v104,s51
buffer_load_dwordx4 v[56:59], v1, s[12:15], s41 offen
mf a[124:127],v[28:31],a[228:231],a[124:127]
pm v22,v116,v112,s51
buffer_load_dwordx4 v[60:63], v1, s[12:15], s42 offen
mf a[156:159],v[28:31],a[232:235],a[156:159]
pm v23,v124,v120,s51
mf a[188:191],v[28:31],a[236:239],a[188:191]
s_waitcnt lgkmcnt(5)
mf a[0:3],v[16:19],a[192:195],a[0:3]
pm v24,v101,v97,s50
s_add_u32 s100, s33, s85
s_waitcnt lgkmcnt(4)
mf a[32:35],v[16:19],a[196:199],a[32:35]
v_add_u32 v1, s100, v0
s_waitcnt lgkmcnt(3)
mf a[64:67],v[16:19],a[200:203],a[64:67]
buffer_load_dwordx4 v[64:67], v1, s[12:15], 0 offen
pm v25,v109,v105,s50
s_waitcnt lgkmcnt(2)
mf a[96:99],v[16:19],a[204:207],a[96:99]
ds_read_b128 a[216:219], v11 offset:0
s_waitcnt lgkmcnt(2)
mf a[128:131],v[16:19],a[208:211],a[128:131]
pm v26,v117,v113,s50
s_waitcnt lgkmcnt(1)
mf a[160:163],v[16:19],a[212:215],a[160:163]
pm v27,v125,v121,s50
buffer_load_dwordx4 v[68:71], v1, s[12:15], s36 offen
mf a[4:7],v[20:23],a[192:195],a[4:7]
pm v28,v101,v97,s51
mf a[36:39],v[20:23],a[196:199],a[36:39]
pm v29,v109,v105,s51
mf a[68:71],v[20:23],a[200:203],a[68:71]
ds_read_b128 a[220:223], v11 offset:4096
pm v30,v117,v113,s51
mf a[100:103],v[20:23],a[204:207],a[100:103]
buffer_load_dwordx4 v[72:75], v1, s[12:15], s37 offen
mf a[132:135],v[20:23],a[208:211],a[132:135]
pm v31,v125,v121,s51
mf a[164:167],v[20:23],a[212:215],a[164:167]
mf a[8:11],v[24:27],a[192:195],a[8:11]
pm v16,v102,v98,s50
buffer_load_dwordx4 v[76:79], v1, s[12:15], s38 offen
mf a[40:43],v[24:27],a[196:199],a[40:43]
pm v17,v110,v106,s50
ds_read_b128 a[224:227], v11 offset:8192
mf a[72:75],v[24:27],a[200:203],a[72:75]
pm v18,v118,v114,s50
mf a[104:107],v[24:27],a[204:207],a[104:107]
s_add_u32 m0, s54, 49152
s_lshr_b32 s47, s34, 12
mf a[136:139],v[24:27],a[208:211],a[136:139]
s_add_u32 s47, s47, 0
mf a[168:171],v[24:27],a[212:215],a[168:171]
buffer_load_dwordx4 v3, s[8:11], s47 offen lds
pm v19,v126,v122,s50
mf a[12:15],v[28:31],a[192:195],a[12:15]
pm v20,v102,v98,s51
mf a[44:47],v[28:31],a[196:199],a[44:47]
buffer_load_dwordx4 v[80:83], v1, s[12:15], s39 offen
pm v21,v110,v106,s51
mf a[76:79],v[28:31],a[200:203],a[76:79]
ds_read_b128 a[228:231], v11 offset:12288
mf a[108:111],v[28:31],a[204:207],a[108:111]
pm v22,v118,v114,s51
buffer_load_dwordx4 v[84:87], v1, s[12:15], s40 offen
mf a[140:143],v[28:31],a[208:211],a[140:143]
pm v23,v126,v122,s51
mf a[172:175],v[28:31],a[212:215],a[172:175]
mf a[16:19],v[16:19],a[192:195],a[16:19]
pm v24,v103,v99,s50
pm v25,v111,v107,s50
mf a[48:51],v[16:19],a[196:199],a[48:51]
buffer_load_dwordx4 v[88:91], v1, s[12:15], s41 offen
mf a[80:83],v[16:19],a[200:203],a[80:83]
ds_read_b128 a[232:235], v11 offset:16384
mf a[112:115],v[16:19],a[204:207],a[112:115]
pm v26,v119,v115,s50
mf a[144:147],v[16:19],a[208:211],a[144:147]
pm v27,v127,v123,s50
mf a[176:179],v[16:19],a[212:215],a[176:179]
pm v28,v103,v99,s51
mf a[20:23],v[20:23],a[192:195],a[20:23]
pm v29,v111,v107,s51
mf a[52:55],v[20:23],a[196:199],a[52:55]
buffer_load_dwordx4 v[92:95], v1, s[12:15], s42 offen
mf a[84:87],v[20:23],a[200:203],a[84:87]
ds_read_b128 a[236:239], v11 offset:20480
mf a[116:119],v[20:23],a[204:207],a[116:119]
pm v30,v119,v115,s51
mf a[148:151],v[20:23],a[208:211],a[148:151]
pm v31,v127,v123,s51
mf a[180:183],v[20:23],a[212:215],a[180:183]
mf a[24:27],v[24:27],a[192:195],a[24:27]
s_waitcnt vmcnt(29)
pm v16,v132,v128,s50
s_add_u32 s100, s33, s86
mf a[56:59],v[24:27],a[196:199],a[56:59]
v_add_u32 v1, s100, v0
mf a[88:91],v[24:27],a[200:203],a[88:91]
buffer_load_dwordx4 v[96:99], v1, s[12:15], 0 offen
s_waitcnt vmcnt(28)
pm v17,v140,v136,s50
mf a[120:123],v[24:27],a[204:207],a[120:123]
s_waitcnt vmcnt(25)
pm v18,v148,v144,s50
mf a[152:155],v[24:27],a[208:211],a[152:155]
s_waitcnt vmcnt(23)
pm v19,v156,v152,s50
s_add_u32 m0, s54, 53248
mf a[184:187],v[24:27],a[212:215],a[184:187]
s_lshr_b32 s47, s34, 12
mf a[28:31],v[28:31],a[192:195],a[28:31]
s_add_u32 s47, s47, 16384
buffer_load_dwordx4 v3, s[8:11], s47 offen lds
mf a[60:63],v[28:31],a[196:199],a[60:63]
pm v20,v132,v128,s51
mf a[92:95],v[28:31],a[200:203],a[92:95]
pm v21,v140,v136,s51
pm v22,v148,v144,s51
mf a[124:127],v[28:31],a[204:207],a[124:127]
buffer_load_dwordx4 v[100:103], v1, s[12:15], s36 offen
mf a[156:159],v[28:31],a[208:211],a[156:159]
pm v23,v156,v152,s51
mf a[188:191],v[28:31],a[212:215],a[188:191]
s_waitcnt vmcnt(14)
s_barrier
s_waitcnt lgkmcnt(5)
mf a[0:3],v[16:19],a[216:219],a[0:3]
pm v24,v133,v129,s50
pm v25,v141,v137,s50
s_waitcnt lgkmcnt(4)
mf a[32:35],v[16:19],a[220:223],a[32:35]
buffer_load_dwordx4 v[104:107], v1, s[12:15], s37 offen
s_waitcnt lgkmcnt(3)
mf a[64:67],v[16:19],a[224:227],a[64:67]
ds_read_b128 a[192:195], v8 offset:24576
s_waitcnt lgkmcnt(3)
mf a[96:99],v[16:19],a[228:231],a[96:99]
pm v26,v149,v145,s50
s_waitcnt lgkmcnt(2)
mf a[128:131],v[16:19],a[232:235],a[128:131]
pm v27,v157,v153,s50
s_waitcnt lgkmcnt(1)
mf a[160:163],v[16:19],a[236:239],a[160:163]
pm v28,v133,v129,s51
mf a[4:7],v[20:23],a[216:219],a[4:7]
pm v29,v141,v137,s51
mf a[36:39],v[20:23],a[220:223],a[36:39]
buffer_load_dwordx4 v[108:111], v1, s[12:15], s38 offen
mf a[68:71],v[20:23],a[224:227],a[68:71]
ds_read_b128 a[196:199], v8 offset:28672
mf a[100:103],v[20:23],a[228:231],a[100:103]
pm v30,v149,v145,s51
mf a[132:135],v[20:23],a[232:235],a[132:135]
pm v31,v157,v153,s51
mf a[164:167],v[20:23],a[236:239],a[164:167]
mf a[8:11],v[24:27],a[216:219],a[8:11]
pm v16,v134,v130,s50
buffer_load_dwordx4 v[112:115], v1, s[12:15], s39 offen
mf a[40:43],v[24:27],a[220:223],a[40:43]
pm v17,v142,v138,s50
mf a[72:75],v[24:27],a[224:227],a[72:75]
ds_read_b128 a[200:203], v8 offset:32768
pm v18,v150,v146,s50
mf a[104:107],v[24:27],a[228:231],a[104:107]
pm v19,v158,v154,s50
mf a[136:139],v[24:27],a[232:235],a[136:139]
s_add_u32 m0, s54, 57344
s_lshr_b32 s47, s34, 12
mf a[168:171],v[24:27],a[236:239],a[168:171]
s_add_u32 s47, s47, 32768
mf a[12:15],v[28:31],a[216:219],a[12:15]
buffer_load_dwordx4 v3, s[8:11], s47 offen lds
pm v20,v134,v130,s51
mf a[44:47],v[28:31],a[220:223],a[44:47]
pm v21,v142,v138,s51
mf a[76:79],v[28:31],a[224:227],a[76:79]
ds_read_b128 a[204:207], v8 offset:36864
pm v22,v150,v146,s51
mf a[108:111],v[28:31],a[228:231],a[108:111]
buffer_load_dwordx4 v[116:119], v1, s[12:15], s40 offen
mf a[140:143],v[28:31],a[232:235],a[140:143]
pm v23,v158,v154,s51
mf a[172:175],v[28:31],a[236:239],a[172:175]
mf a[16:19],v[16:19],a[216:219],a[16:19]
pm v24,v135,v131,s50
pm v25,v143,v139,s50
mf a[48:51],v[16:19],a[220:223],a[48:51]
buffer_load_dwordx4 v[120:123], v1, s[12:15], s41 offen
mf a[80:83],v[16:19],a[224:227],a[80:83]
ds_read_b128 a[208:211], v8 offset:40960
mf a[112:115],v[16:19],a[228:231],a[112:115]
pm v26,v151,v147,s50
mf a[144:147],v[16:19],a[232:235],a[144:147]
pm v27,v159,v155,s50
mf a[176:179],v[16:19],a[236:239],a[176:179]
pm v28,v135,v131,s51
mf a[20:23],v[20:23],a[216:219],a[20:23]
pm v29,v143,v139,s51
mf a[52:55],v[20:23],a[220:223],a[52:55]
buffer_load_dwordx4 v[124:127], v1, s[12:15], s42 offen
mf a[84:87],v[20:23],a[224:227],a[84:87]
ds_read_b128 a[212:215], v8 offset:45056
mf a[116:119],v[20:23],a[228:231],a[116:119]
pm v30,v151,v147,s51
mf a[148:151],v[20:23],a[232:235],a[148:151]
pm v31,v159,v155,s51
mf a[180:183],v[20:23],a[236:239],a[180:183]
mf a[24:27],v[24:27],a[216:219],a[24:27]
pm v16,v36,v32,s50
s_add_u32 s100, s33, s87
mf a[56:59],v[24:27],a[220:223],a[56:59]
v_add_u32 v1, s100, v0
mf a[88:91],v[24:27],a[224:227],a[88:91]
buffer_load_dwordx4 v[128:131], v1, s[12:15], 0 offen
pm v17,v44,v40,s50
mf a[120:123],v[24:27],a[228:231],a[120:123]
pm v18,v52,v48,s50
mf a[152:155],v[24:27],a[232:235],a[152:155]
s_waitcnt vmcnt(20)
pm v19,v60,v56,s50
s_add_u32 m0, s54, 61440
mf a[184:187],v[24:27],a[236:239],a[184:187]
s_lshr_b32 s47, s34, 12
mf a[28:31],v[28:31],a[216:219],a[28:31]
s_add_u32 s47, s47, 49152
buffer_load_dwordx4 v3, s[8:11], s47 offen lds
mf a[60:63],v[28:31],a[220:223],a[60:63]
pm v20,v36,v32,s51
mf a[92:95],v[28:31],a[224:227],a[92:95]
pm v21,v44,v40,s51
pm v22,v52,v48,s51
mf a[124:127],v[28:31],a[228:231],a[124:127]
buffer_load_dwordx4 v[132:135], v1, s[12:15], s36 offen
mf a[156:159],v[28:31],a[232:235],a[156:159]
pm v23,v60,v56,s51
mf a[188:191],v[28:31],a[236:239],a[188:191]
s_waitcnt lgkmcnt(5)
mf a[0:3],v[16:19],a[192:195],a[0:3]
pm v24,v37,v33,s50
pm v25,v45,v41,s50
s_waitcnt lgkmcnt(4)
mf a[32:35],v[16:19],a[196:199],a[32:35]
buffer_load_dwordx4 v[136:139], v1, s[12:15], s37 offen
s_waitcnt lgkmcnt(3)
mf a[64:67],v[16:19],a[200:203],a[64:67]
ds_read_b128 a[216:219], v9 offset:24576
s_waitcnt lgkmcnt(3)
mf a[96:99],v[16:19],a[204:207],a[96:99]
pm v26,v53,v49,s50
s_waitcnt lgkmcnt(2)
mf a[128:131],v[16:19],a[208:211],a[128:131]
pm v27,v61,v57,s50
s_waitcnt lgkmcnt(1)
mf a[160:163],v[16:19],a[212:215],a[160:163]
pm v28,v37,v33,s51
mf a[4:7],v[20:23],a[192:195],a[4:7]
pm v29,v45,v41,s51
mf a[36:39],v[20:23],a[196:199],a[36:39]
buffer_load_dwordx4 v[140:143], v1, s[12:15], s38 offen
mf a[68:71],v[20:23],a[200:203],a[68:71]
ds_read_b128 a[220:223], v9 offset:28672
mf a[100:103],v[20:23],a[204:207],a[100:103]
pm v30,v53,v49,s51
mf a[132:135],v[20:23],a[208:211],a[132:135]
pm v31,v61,v57,s51
mf a[164:167],v[20:23],a[212:215],a[164:167]
mf a[8:11],v[24:27],a[192:195],a[8:11]
pm v16,v38,v34,s50
buffer_load_dwordx4 v[144:147], v1, s[12:15], s39 offen
mf a[40:43],v[24:27],a[196:199],a[40:43]
pm v17,v46,v42,s50
mf a[72:75],v[24:27],a[200:203],a[72:75]
ds_read_b128 a[224:227], v9 offset:32768
pm v18,v54,v50,s50
mf a[104:107],v[24:27],a[204:207],a[104:107]
pm v19,v62,v58,s50
mf a[136:139],v[24:27],a[208:211],a[136:139]
s_add_u32 m0, s54, 65536
s_lshr_b32 s47, s34, 12
mf a[168:171],v[24:27],a[212:215],a[168:171]
s_add_u32 s47, s47, 65536
mf a[12:15],v[28:31],a[192:195],a[12:15]
buffer_load_dwordx4 v3, s[8:11], s47 offen lds
pm v20,v38,v34,s51
mf a[44:47],v[28:31],a[196:199],a[44:47]
pm v21,v46,v42,s51
mf a[76:79],v[28:31],a[200:203],a[76:79]
ds_read_b128 a[228:231], v9 offset:36864
pm v22,v54,v50,s51
mf a[108:111],v[28:31],a[204:207],a[108:111]
buffer_load_dwordx4 v[148:151], v1, s[12:15], s40 offen
mf a[140:143],v[28:31],a[208:211],a[140:143]
pm v23,v62,v58,s51
mf a[172:175],v[28:31],a[212:215],a[172:175]
mf a[16:19],v[16:19],a[192:195],a[16:19]
pm v24,v39,v35,s50
buffer_load_dwordx4 v[152:155], v1, s[12:15], s41 offen
mf a[48:51],v[16:19],a[196:199],a[48:51]
pm v25,v47,v43,s50
mf a[80:83],v[16:19],a[200:203],a[80:83]
ds_read_b128 a[232:235], v9 offset:40960
pm v26,v55,v51,s50
mf a[112:115],v[16:19],a[204:207],a[112:115]
pm v27,v63,v59,s50
mf a[144:147],v[16:19],a[208:211],a[144:147]
s_add_u32 m0, s54, 69632
s_lshr_b32 s47, s34, 12
mf a[176:179],v[16:19],a[212:215],a[176:179]
s_add_u32 s47, s47, 81920
mf a[20:23],v[20:23],a[192:195],a[20:23]
buffer_load_dwordx4 v3, s[8:11], s47 offen lds
pm v28,v39,v35,s51
mf a[52:55],v[20:23],a[196:199],a[52:55]
pm v29,v47,v43,s51
mf a[84:87],v[20:23],a[200:203],a[84:87]
ds_read_b128 a[236:239], v9 offset:45056
pm v30,v55,v51,s51
mf a[116:119],v[20:23],a[204:207],a[116:119]
buffer_load_dwordx4 v[156:159], v1, s[12:15], s42 offen
mf a[148:151],v[20:23],a[208:211],a[148:151]
pm v31,v63,v59,s51
mf a[180:183],v[20:23],a[212:215],a[180:183]
mf a[24:27],v[24:27],a[192:195],a[24:27]
s_waitcnt vmcnt(28)
pm v16,v68,v64,s50
s_add_u32 s100, s34, s84
mf a[56:59],v[24:27],a[196:199],a[56:59]
v_add_u32 v1, s100, v0
mf a[88:91],v[24:27],a[200:203],a[88:91]
buffer_load_dwordx4 v[32:35], v1, s[12:15], 0 offen
s_waitcnt vmcnt(27)
pm v17,v76,v72,s50
mf a[120:123],v[24:27],a[204:207],a[120:123]
s_waitcnt vmcnt(24)
pm v18,v84,v80,s50
mf a[152:155],v[24:27],a[208:211],a[152:155]
s_waitcnt vmcnt(22)
pm v19,v92,v88,s50
s_add_u32 m0, s54, 73728
mf a[184:187],v[24:27],a[212:215],a[184:187]
s_lshr_b32 s47, s35, 12
mf a[28:31],v[28:31],a[192:195],a[28:31]
s_add_u32 s47, s47, 0
buffer_load_dwordx4 v3, s[8:11], s47 offen lds
mf a[60:63],v[28:31],a[196:199],a[60:63]
pm v20,v68,v64,s51
mf a[92:95],v[28:31],a[200:203],a[92:95]
pm v21,v76,v72,s51
pm v22,v84,v80,s51
mf a[124:127],v[28:31],a[204:207],a[124:127]
buffer_load_dwordx4 v[36:39], v1, s[12:15], s36 offen
mf a[156:159],v[28:31],a[208:211],a[156:159]
pm v23,v92,v88,s51
mf a[188:191],v[28:31],a[212:215],a[188:191]
s_waitcnt lgkmcnt(5)
mf a[0:3],v[16:19],a[216:219],a[0:3]
pm v24,v69,v65,s50
pm v25,v77,v73,s50
s_waitcnt lgkmcnt(4)
mf a[32:35],v[16:19],a[220:223],a[32:35]
buffer_load_dwordx4 v[40:43], v1, s[12:15], s37 offen
s_waitcnt lgkmcnt(3)
mf a[64:67],v[16:19],a[224:227],a[64:67]
ds_read_b128 a[192:195], v10 offset:24576
s_waitcnt lgkmcnt(3)
mf a[96:99],v[16:19],a[228:231],a[96:99]
pm v26,v85,v81,s50
s_waitcnt lgkmcnt(2)
mf a[128:131],v[16:19],a[232:235],a[128:131]
pm v27,v93,v89,s50
s_waitcnt lgkmcnt(1)
mf a[160:163],v[16:19],a[236:239],a[160:163]
pm v28,v69,v65,s51
mf a[4:7],v[20:23],a[216:219],a[4:7]
pm v29,v77,v73,s51
mf a[36:39],v[20:23],a[220:223],a[36:39]
buffer_load_dwordx4 v[44:47], v1, s[12:15], s38 offen
mf a[68:71],v[20:23],a[224:227],a[68:71]
ds_read_b128 a[196:199], v10 offset:28672
mf a[100:103],v[20:23],a[228:231],a[100:103]
pm v30,v85,v81,s51
mf a[132:135],v[20:23],a[232:235],a[132:135]
pm v31,v93,v89,s51
mf a[164:167],v[20:23],a[236:239],a[164:167]
mf a[8:11],v[24:27],a[216:219],a[8:11]
pm v16,v70,v66,s50
buffer_load_dwordx4 v[48:51], v1, s[12:15], s39 offen
mf a[40:43],v[24:27],a[220:223],a[40:43]
pm v17,v78,v74,s50
mf a[72:75],v[24:27],a[224:227],a[72:75]
ds_read_b128 a[200:203], v10 offset:32768
pm v18,v86,v82,s50
mf a[104:107],v[24:27],a[228:231],a[104:107]
pm v19,v94,v90,s50
mf a[136:139],v[24:27],a[232:235],a[136:139]
s_add_u32 m0, s54, 77824
s_lshr_b32 s47, s35, 12
mf a[168:171],v[24:27],a[236:239],a[168:171]
s_add_u32 s47, s47, 16384
mf a[12:15],v[28:31],a[216:219],a[12:15]
buffer_load_dwordx4 v3, s[8:11], s47 offen lds
pm v20,v70,v66,s51
mf a[44:47],v[28:31],a[220:223],a[44:47]
pm v21,v78,v74,s51
mf a[76:79],v[28:31],a[224:227],a[76:79]
ds_read_b128 a[204:207], v10 offset:36864
pm v22,v86,v82,s51
mf a[108:111],v[28:31],a[228:231],a[108:111]
buffer_load_dwordx4 v[52:55], v1, s[12:15], s40 offen
mf a[140:143],v[28:31],a[232:235],a[140:143]
pm v23,v94,v90,s51
mf a[172:175],v[28:31],a[236:239],a[172:175]
mf a[16:19],v[16:19],a[216:219],a[16:19]
pm v24,v71,v67,s50
pm v25,v79,v75,s50
mf a[48:51],v[16:19],a[220:223],a[48:51]
buffer_load_dwordx4 v[56:59], v1, s[12:15], s41 offen
mf a[80:83],v[16:19],a[224:227],a[80:83]
ds_read_b128 a[208:211], v10 offset:40960
mf a[112:115],v[16:19],a[228:231],a[112:115]
pm v26,v87,v83,s50
mf a[144:147],v[16:19],a[232:235],a[144:147]
pm v27,v95,v91,s50
mf a[176:179],v[16:19],a[236:239],a[176:179]
pm v28,v71,v67,s51
mf a[20:23],v[20:23],a[216:219],a[20:23]
pm v29,v79,v75,s51
mf a[52:55],v[20:23],a[220:223],a[52:55]
buffer_load_dwordx4 v[60:63], v1, s[12:15], s42 offen
mf a[84:87],v[20:23],a[224:227],a[84:87]
ds_read_b128 a[212:215], v10 offset:45056
mf a[116:119],v[20:23],a[228:231],a[116:119]
pm v30,v87,v83,s51
mf a[148:151],v[20:23],a[232:235],a[148:151]
pm v31,v95,v91,s51
mf a[180:183],v[20:23],a[236:239],a[180:183]
mf a[24:27],v[24:27],a[216:219],a[24:27]
s_waitcnt vmcnt(28)
pm v16,v100,v96,s50
s_add_u32 s100, s34, s85
mf a[56:59],v[24:27],a[220:223],a[56:59]
v_add_u32 v1, s100, v0
mf a[88:91],v[24:27],a[224:227],a[88:91]
buffer_load_dwordx4 v[64:67], v1, s[12:15], 0 offen
s_waitcnt vmcnt(27)
pm v17,v108,v104,s50
mf a[120:123],v[24:27],a[228:231],a[120:123]
s_waitcnt vmcnt(24)
pm v18,v116,v112,s50
mf a[152:155],v[24:27],a[232:235],a[152:155]
s_waitcnt vmcnt(22)
pm v19,v124,v120,s50
s_add_u32 m0, s54, 81920
mf a[184:187],v[24:27],a[236:239],a[184:187]
s_lshr_b32 s47, s35, 12
mf a[28:31],v[28:31],a[216:219],a[28:31]
s_add_u32 s47, s47, 32768
buffer_load_dwordx4 v3, s[8:11], s47 offen lds
mf a[60:63],v[28:31],a[220:223],a[60:63]
pm v20,v100,v96,s51
mf a[92:95],v[28:31],a[224:227],a[92:95]
pm v21,v108,v104,s51
pm v22,v116,v112,s51
mf a[124:127],v[28:31],a[228:231],a[124:127]
buffer_load_dwordx4 v[68:71], v1, s[12:15], s36 offen
mf a[156:159],v[28:31],a[232:235],a[156:159]
pm v23,v124,v120,s51
mf a[188:191],v[28:31],a[236:239],a[188:191]
s_waitcnt lgkmcnt(5)
mf a[0:3],v[16:19],a[192:195],a[0:3]
pm v24,v101,v97,s50
pm v25,v109,v105,s50
s_waitcnt lgkmcnt(4)
mf a[32:35],v[16:19],a[196:199],a[32:35]
buffer_load_dwordx4 v[72:75], v1, s[12:15], s37 offen
s_waitcnt lgkmcnt(3)
mf a[64:67],v[16:19],a[200:203],a[64:67]
ds_read_b128 a[216:219], v11 offset:24576
s_waitcnt lgkmcnt(3)
mf a[96:99],v[16:19],a[204:207],a[96:99]
pm v26,v117,v113,s50
s_waitcnt lgkmcnt(2)
mf a[128:131],v[16:19],a[208:211],a[128:131]
pm v27,v125,v121,s50
s_waitcnt lgkmcnt(1)
mf a[160:163],v[16:19],a[212:215],a[160:163]
pm v28,v101,v97,s51
mf a[4:7],v[20:23],a[192:195],a[4:7]
pm v29,v109,v105,s51
mf a[36:39],v[20:23],a[196:199],a[36:39]
buffer_load_dwordx4 v[76:79], v1, s[12:15], s38 offen
mf a[68:71],v[20:23],a[200:203],a[68:71]
ds_read_b128 a[220:223], v11 offset:28672
mf a[100:103],v[20:23],a[204:207],a[100:103]
pm v30,v117,v113,s51
mf a[132:135],v[20:23],a[208:211],a[132:135]
pm v31,v125,v121,s51
mf a[164:167],v[20:23],a[212:215],a[164:167]
mf a[8:11],v[24:27],a[192:195],a[8:11]
pm v16,v102,v98,s50
buffer_load_dwordx4 v[80:83], v1, s[12:15], s39 offen
mf a[40:43],v[24:27],a[196:199],a[40:43]
pm v17,v110,v106,s50
mf a[72:75],v[24:27],a[200:203],a[72:75]
ds_read_b128 a[224:227], v11 offset:32768
pm v18,v118,v114,s50
mf a[104:107],v[24:27],a[204:207],a[104:107]
pm v19,v126,v122,s50
mf a[136:139],v[24:27],a[208:211],a[136:139]
s_add_u32 m0, s54, 86016
s_lshr_b32 s47, s35, 12
mf a[168:171],v[24:27],a[212:215],a[168:171]
s_add_u32 s47, s47, 49152
mf a[12:15],v[28:31],a[192:195],a[12:15]
buffer_load_dwordx4 v3, s[8:11], s47 offen lds
pm v20,v102,v98,s51
mf a[44:47],v[28:31],a[196:199],a[44:47]
pm v21,v110,v106,s51
mf a[76:79],v[28:31],a[200:203],a[76:79]
ds_read_b128 a[228:231], v11 offset:36864
pm v22,v118,v114,s51
mf a[108:111],v[28:31],a[204:207],a[108:111]
buffer_load_dwordx4 v[84:87], v1, s[12:15], s40 offen
mf a[140:143],v[28:31],a[208:211],a[140:143]
pm v23,v126,v122,s51
mf a[172:175],v[28:31],a[212:215],a[172:175]
mf a[16:19],v[16:19],a[192:195],a[16:19]
pm v24,v103,v99,s50
buffer_load_dwordx4 v[88:91], v1, s[12:15], s41 offen
mf a[48:51],v[16:19],a[196:199],a[48:51]
pm v25,v111,v107,s50
mf a[80:83],v[16:19],a[200:203],a[80:83]
ds_read_b128 a[232:235], v11 offset:40960
pm v26,v119,v115,s50
mf a[112:115],v[16:19],a[204:207],a[112:115]
pm v27,v127,v123,s50
mf a[144:147],v[16:19],a[208:211],a[144:147]
s_add_u32 m0, s54, 90112
s_lshr_b32 s47, s35, 12
mf a[176:179],v[16:19],a[212:215],a[176:179]
s_add_u32 s47, s47, 65536
mf a[20:23],v[20:23],a[192:195],a[20:23]
buffer_load_dwordx4 v3, s[8:11], s47 offen lds
pm v28,v103,v99,s51
mf a[52:55],v[20:23],a[196:199],a[52:55]
pm v29,v111,v107,s51
mf a[84:87],v[20:23],a[200:203],a[84:87]
ds_read_b128 a[236:239], v11 offset:45056
pm v30,v119,v115,s51
mf a[116:119],v[20:23],a[204:207],a[116:119]
buffer_load_dwordx4 v[92:95], v1, s[12:15], s42 offen
mf a[148:151],v[20:23],a[208:211],a[148:151]
pm v31,v127,v123,s51
mf a[180:183],v[20:23],a[212:215],a[180:183]
mf a[24:27],v[24:27],a[192:195],a[24:27]
s_waitcnt vmcnt(29)
pm v16,v132,v128,s50
s_add_u32 s100, s34, s86
mf a[56:59],v[24:27],a[196:199],a[56:59]
v_add_u32 v1, s100, v0
mf a[88:91],v[24:27],a[200:203],a[88:91]
buffer_load_dwordx4 v[96:99], v1, s[12:15], 0 offen
s_waitcnt vmcnt(28)
pm v17,v140,v136,s50
mf a[120:123],v[24:27],a[204:207],a[120:123]
s_waitcnt vmcnt(25)
pm v18,v148,v144,s50
mf a[152:155],v[24:27],a[208:211],a[152:155]
s_waitcnt vmcnt(22)
pm v19,v156,v152,s50
s_add_u32 m0, s54, 94208
mf a[184:187],v[24:27],a[212:215],a[184:187]
s_lshr_b32 s47, s35, 12
mf a[28:31],v[28:31],a[192:195],a[28:31]
s_add_u32 s47, s47, 81920
buffer_load_dwordx4 v3, s[8:11], s47 offen lds
mf a[60:63],v[28:31],a[196:199],a[60:63]
pm v20,v132,v128,s51
mf a[92:95],v[28:31],a[200:203],a[92:95]
pm v21,v140,v136,s51
pm v22,v148,v144,s51
mf a[124:127],v[28:31],a[204:207],a[124:127]
buffer_load_dwordx4 v[100:103], v1, s[12:15], s36 offen
mf a[156:159],v[28:31],a[208:211],a[156:159]
pm v23,v156,v152,s51
mf a[188:191],v[28:31],a[212:215],a[188:191]
s_barrier
s_waitcnt lgkmcnt(5)
mf a[0:3],v[16:19],a[216:219],a[0:3]
pm v24,v133,v129,s50
pm v25,v141,v137,s50
s_waitcnt lgkmcnt(4)
mf a[32:35],v[16:19],a[220:223],a[32:35]
buffer_load_dwordx4 v[104:107], v1, s[12:15], s37 offen
s_waitcnt lgkmcnt(3)
mf a[64:67],v[16:19],a[224:227],a[64:67]
v_add_u32 v8, 0xc000, v8
v_add_u32 v9, 0xc000, v9
s_waitcnt lgkmcnt(2)
mf a[96:99],v[16:19],a[228:231],a[96:99]
v_add_u32 v10, 0xc000, v10
s_waitcnt lgkmcnt(1)
mf a[128:131],v[16:19],a[232:235],a[128:131]
v_add_u32 v11, 0xc000, v11
ds_read_b128 a[192:195], v8 offset:0
s_waitcnt lgkmcnt(1)
mf a[160:163],v[16:19],a[236:239],a[160:163]
pm v26,v149,v145,s50
mf a[4:7],v[20:23],a[216:219],a[4:7]
pm v27,v157,v153,s50
pm v28,v133,v129,s51
mf a[36:39],v[20:23],a[220:223],a[36:39]
pm v29,v141,v137,s51
mf a[68:71],v[20:23],a[224:227],a[68:71]
buffer_load_dwordx4 v[108:111], v1, s[12:15], s38 offen
ds_read_b128 a[196:199], v8 offset:4096
mf a[100:103],v[20:23],a[228:231],a[100:103]
pm v30,v149,v145,s51
mf a[132:135],v[20:23],a[232:235],a[132:135]
pm v31,v157,v153,s51
mf a[164:167],v[20:23],a[236:239],a[164:167]
mf a[8:11],v[24:27],a[216:219],a[8:11]
pm v16,v134,v130,s50
pm v17,v142,v138,s50
mf a[40:43],v[24:27],a[220:223],a[40:43]
buffer_load_dwordx4 v[112:115], v1, s[12:15], s39 offen
mf a[72:75],v[24:27],a[224:227],a[72:75]
ds_read_b128 a[200:203], v8 offset:8192
mf a[104:107],v[24:27],a[228:231],a[104:107]
pm v18,v150,v146,s50
mf a[136:139],v[24:27],a[232:235],a[136:139]
pm v19,v158,v154,s50
mf a[168:171],v[24:27],a[236:239],a[168:171]
pm v20,v134,v130,s51
mf a[12:15],v[28:31],a[216:219],a[12:15]
pm v21,v142,v138,s51
mf a[44:47],v[28:31],a[220:223],a[44:47]
buffer_load_dwordx4 v[116:119], v1, s[12:15], s40 offen
mf a[76:79],v[28:31],a[224:227],a[76:79]
ds_read_b128 a[204:207], v8 offset:12288
mf a[108:111],v[28:31],a[228:231],a[108:111]
pm v22,v150,v146,s51
mf a[140:143],v[28:31],a[232:235],a[140:143]
pm v23,v158,v154,s51
mf a[172:175],v[28:31],a[236:239],a[172:175]
mf a[16:19],v[16:19],a[216:219],a[16:19]
pm v24,v135,v131,s50
pm v25,v143,v139,s50
mf a[48:51],v[16:19],a[220:223],a[48:51]
buffer_load_dwordx4 v[120:123], v1, s[12:15], s41 offen
mf a[80:83],v[16:19],a[224:227],a[80:83]
ds_read_b128 a[208:211], v8 offset:16384
mf a[112:115],v[16:19],a[228:231],a[112:115]
pm v26,v151,v147,s50
mf a[144:147],v[16:19],a[232:235],a[144:147]
pm v27,v159,v155,s50
mf a[176:179],v[16:19],a[236:239],a[176:179]
pm v28,v135,v131,s51
mf a[20:23],v[20:23],a[216:219],a[20:23]
pm v29,v143,v139,s51
mf a[52:55],v[20:23],a[220:223],a[52:55]
buffer_load_dwordx4 v[124:127], v1, s[12:15], s42 offen
mf a[84:87],v[20:23],a[224:227],a[84:87]
ds_read_b128 a[212:215], v8 offset:20480
mf a[116:119],v[20:23],a[228:231],a[116:119]
pm v30,v151,v147,s51
mf a[148:151],v[20:23],a[232:235],a[148:151]
pm v31,v159,v155,s51
mf a[180:183],v[20:23],a[236:239],a[180:183]
mf a[24:27],v[24:27],a[216:219],a[24:27]
s_waitcnt vmcnt(27)
pm v16,v36,v32,s50
s_waitcnt vmcnt(25)
pm v17,v44,v40,s50
mf a[56:59],v[24:27],a[220:223],a[56:59]
s_add_u32 s100, s34, s87
mf a[88:91],v[24:27],a[224:227],a[88:91]
v_add_u32 v1, s100, v0
mf a[120:123],v[24:27],a[228:231],a[120:123]
buffer_load_dwordx4 v[128:131], v1, s[12:15], 0 offen
mf a[152:155],v[24:27],a[232:235],a[152:155]
s_waitcnt vmcnt(23)
pm v18,v52,v48,s50
mf a[184:187],v[24:27],a[236:239],a[184:187]
s_waitcnt vmcnt(21)
pm v19,v60,v56,s50
mf a[28:31],v[28:31],a[216:219],a[28:31]
pm v20,v36,v32,s51
mf a[60:63],v[28:31],a[220:223],a[60:63]
pm v21,v44,v40,s51
mf a[92:95],v[28:31],a[224:227],a[92:95]
buffer_load_dwordx4 v[132:135], v1, s[12:15], s36 offen
mf a[124:127],v[28:31],a[228:231],a[124:127]
pm v22,v52,v48,s51
mf a[156:159],v[28:31],a[232:235],a[156:159]
pm v23,v60,v56,s51
mf a[188:191],v[28:31],a[236:239],a[188:191]
s_waitcnt lgkmcnt(5)
mf a[0:3],v[16:19],a[192:195],a[0:3]
pm v24,v37,v33,s50
pm v25,v45,v41,s50
s_waitcnt lgkmcnt(4)
mf a[32:35],v[16:19],a[196:199],a[32:35]
buffer_load_dwordx4 v[136:139], v1, s[12:15], s37 offen
s_waitcnt lgkmcnt(3)
mf a[64:67],v[16:19],a[200:203],a[64:67]
ds_read_b128 a[216:219], v9 offset:0
s_waitcnt lgkmcnt(3)
mf a[96:99],v[16:19],a[204:207],a[96:99]
pm v26,v53,v49,s50
s_waitcnt lgkmcnt(2)
mf a[128:131],v[16:19],a[208:211],a[128:131]
pm v27,v61,v57,s50
s_waitcnt lgkmcnt(1)
mf a[160:163],v[16:19],a[212:215],a[160:163]
pm v28,v37,v33,s51
mf a[4:7],v[20:23],a[192:195],a[4:7]
pm v29,v45,v41,s51
mf a[36:39],v[20:23],a[196:199],a[36:39]
buffer_load_dwordx4 v[140:143], v1, s[12:15], s38 offen
mf a[68:71],v[20:23],a[200:203],a[68:71]
ds_read_b128 a[220:223], v9 offset:4096
mf a[100:103],v[20:23],a[204:207],a[100:103]
pm v30,v53,v49,s51
mf a[132:135],v[20:23],a[208:211],a[132:135]
pm v31,v61,v57,s51
mf a[164:167],v[20:23],a[212:215],a[164:167]
mf a[8:11],v[24:27],a[192:195],a[8:11]
pm v16,v38,v34,s50
pm v17,v46,v42,s50
mf a[40:43],v[24:27],a[196:199],a[40:43]
buffer_load_dwordx4 v[144:147], v1, s[12:15], s39 offen
mf a[72:75],v[24:27],a[200:203],a[72:75]
ds_read_b128 a[224:227], v9 offset:8192
mf a[104:107],v[24:27],a[204:207],a[104:107]
pm v18,v54,v50,s50
mf a[136:139],v[24:27],a[208:211],a[136:139]
pm v19,v62,v58,s50
mf a[168:171],v[24:27],a[212:215],a[168:171]
pm v20,v38,v34,s51
mf a[12:15],v[28:31],a[192:195],a[12:15]
pm v21,v46,v42,s51
mf a[44:47],v[28:31],a[196:199],a[44:47]
buffer_load_dwordx4 v[148:151], v1, s[12:15], s40 offen
mf a[76:79],v[28:31],a[200:203],a[76:79]
ds_read_b128 a[228:231], v9 offset:12288
mf a[108:111],v[28:31],a[204:207],a[108:111]
pm v22,v54,v50,s51
mf a[140:143],v[28:31],a[208:211],a[140:143]
pm v23,v62,v58,s51
mf a[172:175],v[28:31],a[212:215],a[172:175]
mf a[16:19],v[16:19],a[192:195],a[16:19]
pm v24,v39,v35,s50
pm v25,v47,v43,s50
mf a[48:51],v[16:19],a[196:199],a[48:51]
buffer_load_dwordx4 v[152:155], v1, s[12:15], s41 offen
mf a[80:83],v[16:19],a[200:203],a[80:83]
ds_read_b128 a[232:235], v9 offset:16384
mf a[112:115],v[16:19],a[204:207],a[112:115]
pm v26,v55,v51,s50
mf a[144:147],v[16:19],a[208:211],a[144:147]
pm v27,v63,v59,s50
mf a[176:179],v[16:19],a[212:215],a[176:179]
pm v28,v39,v35,s51
mf a[20:23],v[20:23],a[192:195],a[20:23]
pm v29,v47,v43,s51
mf a[52:55],v[20:23],a[196:199],a[52:55]
buffer_load_dwordx4 v[156:159], v1, s[12:15], s42 offen
mf a[84:87],v[20:23],a[200:203],a[84:87]
ds_read_b128 a[236:239], v9 offset:20480
mf a[116:119],v[20:23],a[204:207],a[116:119]
pm v30,v55,v51,s51
mf a[148:151],v[20:23],a[208:211],a[148:151]
pm v31,v63,v59,s51
mf a[180:183],v[20:23],a[212:215],a[180:183]
mf a[24:27],v[24:27],a[192:195],a[24:27]
s_waitcnt vmcnt(25)
pm v16,v68,v64,s50
s_waitcnt vmcnt(23)
pm v17,v76,v72,s50
mf a[56:59],v[24:27],a[196:199],a[56:59]
s_add_u32 s100, s35, s84
mf a[88:91],v[24:27],a[200:203],a[88:91]
v_add_u32 v1, s100, v0
mf a[120:123],v[24:27],a[204:207],a[120:123]
buffer_load_dwordx4 v[32:35], v1, s[12:15], 0 offen
mf a[152:155],v[24:27],a[208:211],a[152:155]
s_waitcnt vmcnt(21)
pm v18,v84,v80,s50
mf a[184:187],v[24:27],a[212:215],a[184:187]
s_waitcnt vmcnt(18)
pm v19,v92,v88,s50
mf a[28:31],v[28:31],a[192:195],a[28:31]
pm v20,v68,v64,s51
mf a[60:63],v[28:31],a[196:199],a[60:63]
pm v21,v76,v72,s51
mf a[92:95],v[28:31],a[200:203],a[92:95]
buffer_load_dwordx4 v[36:39], v1, s[12:15], s36 offen
mf a[124:127],v[28:31],a[204:207],a[124:127]
pm v22,v84,v80,s51
mf a[156:159],v[28:31],a[208:211],a[156:159]
pm v23,v92,v88,s51
mf a[188:191],v[28:31],a[212:215],a[188:191]
s_waitcnt lgkmcnt(5)
mf a[0:3],v[16:19],a[216:219],a[0:3]
pm v24,v69,v65,s50
pm v25,v77,v73,s50
s_waitcnt lgkmcnt(4)
mf a[32:35],v[16:19],a[220:223],a[32:35]
buffer_load_dwordx4 v[40:43], v1, s[12:15], s37 offen
s_waitcnt lgkmcnt(3)
mf a[64:67],v[16:19],a[224:227],a[64:67]
ds_read_b128 a[192:195], v10 offset:0
s_waitcnt lgkmcnt(3)
mf a[96:99],v[16:19],a[228:231],a[96:99]
pm v26,v85,v81,s50
s_waitcnt lgkmcnt(2)
mf a[128:131],v[16:19],a[232:235],a[128:131]
pm v27,v93,v89,s50
s_waitcnt lgkmcnt(1)
mf a[160:163],v[16:19],a[236:239],a[160:163]
pm v28,v69,v65,s51
mf a[4:7],v[20:23],a[216:219],a[4:7]
pm v29,v77,v73,s51
mf a[36:39],v[20:23],a[220:223],a[36:39]
buffer_load_dwordx4 v[44:47], v1, s[12:15], s38 offen
mf a[68:71],v[20:23],a[224:227],a[68:71]
ds_read_b128 a[196:199], v10 offset:4096
mf a[100:103],v[20:23],a[228:231],a[100:103]
pm v30,v85,v81,s51
mf a[132:135],v[20:23],a[232:235],a[132:135]
pm v31,v93,v89,s51
mf a[164:167],v[20:23],a[236:239],a[164:167]
mf a[8:11],v[24:27],a[216:219],a[8:11]
pm v16,v70,v66,s50
pm v17,v78,v74,s50
mf a[40:43],v[24:27],a[220:223],a[40:43]
buffer_load_dwordx4 v[48:51], v1, s[12:15], s39 offen
mf a[72:75],v[24:27],a[224:227],a[72:75]
ds_read_b128 a[200:203], v10 offset:8192
mf a[104:107],v[24:27],a[228:231],a[104:107]
pm v18,v86,v82,s50
mf a[136:139],v[24:27],a[232:235],a[136:139]
pm v19,v94,v90,s50
mf a[168:171],v[24:27],a[236:239],a[168:171]
pm v20,v70,v66,s51
mf a[12:15],v[28:31],a[216:219],a[12:15]
pm v21,v78,v74,s51
mf a[44:47],v[28:31],a[220:223],a[44:47]
buffer_load_dwordx4 v[52:55], v1, s[12:15], s40 offen
mf a[76:79],v[28:31],a[224:227],a[76:79]
ds_read_b128 a[204:207], v10 offset:12288
mf a[108:111],v[28:31],a[228:231],a[108:111]
pm v22,v86,v82,s51
mf a[140:143],v[28:31],a[232:235],a[140:143]
pm v23,v94,v90,s51
mf a[172:175],v[28:31],a[236:239],a[172:175]
mf a[16:19],v[16:19],a[216:219],a[16:19]
pm v24,v71,v67,s50
pm v25,v79,v75,s50
mf a[48:51],v[16:19],a[220:223],a[48:51]
buffer_load_dwordx4 v[56:59], v1, s[12:15], s41 offen
mf a[80:83],v[16:19],a[224:227],a[80:83]
ds_read_b128 a[208:211], v10 offset:16384
mf a[112:115],v[16:19],a[228:231],a[112:115]
pm v26,v87,v83,s50
mf a[144:147],v[16:19],a[232:235],a[144:147]
pm v27,v95,v91,s50
mf a[176:179],v[16:19],a[236:239],a[176:179]
pm v28,v71,v67,s51
mf a[20:23],v[20:23],a[216:219],a[20:23]
pm v29,v79,v75,s51
mf a[52:55],v[20:23],a[220:223],a[52:55]
buffer_load_dwordx4 v[60:63], v1, s[12:15], s42 offen
mf a[84:87],v[20:23],a[224:227],a[84:87]
ds_read_b128 a[212:215], v10 offset:20480
mf a[116:119],v[20:23],a[228:231],a[116:119]
pm v30,v87,v83,s51
mf a[148:151],v[20:23],a[232:235],a[148:151]
pm v31,v95,v91,s51
mf a[180:183],v[20:23],a[236:239],a[180:183]
mf a[24:27],v[24:27],a[216:219],a[24:27]
s_waitcnt vmcnt(22)
pm v16,v100,v96,s50
s_waitcnt vmcnt(20)
pm v17,v108,v104,s50
mf a[56:59],v[24:27],a[220:223],a[56:59]
s_add_u32 s100, s35, s85
mf a[88:91],v[24:27],a[224:227],a[88:91]
v_add_u32 v1, s100, v0
mf a[120:123],v[24:27],a[228:231],a[120:123]
buffer_load_dwordx4 v[64:67], v1, s[12:15], 0 offen
mf a[152:155],v[24:27],a[232:235],a[152:155]
s_waitcnt vmcnt(19)
pm v18,v116,v112,s50
mf a[184:187],v[24:27],a[236:239],a[184:187]
s_waitcnt vmcnt(17)
pm v19,v124,v120,s50
mf a[28:31],v[28:31],a[216:219],a[28:31]
pm v20,v100,v96,s51
mf a[60:63],v[28:31],a[220:223],a[60:63]
pm v21,v108,v104,s51
mf a[92:95],v[28:31],a[224:227],a[92:95]
buffer_load_dwordx4 v[68:71], v1, s[12:15], s36 offen
mf a[124:127],v[28:31],a[228:231],a[124:127]
pm v22,v116,v112,s51
mf a[156:159],v[28:31],a[232:235],a[156:159]
pm v23,v124,v120,s51
mf a[188:191],v[28:31],a[236:239],a[188:191]
s_waitcnt lgkmcnt(5)
mf a[0:3],v[16:19],a[192:195],a[0:3]
pm v24,v101,v97,s50
pm v25,v109,v105,s50
s_waitcnt lgkmcnt(4)
mf a[32:35],v[16:19],a[196:199],a[32:35]
buffer_load_dwordx4 v[72:75], v1, s[12:15], s37 offen
s_waitcnt lgkmcnt(3)
mf a[64:67],v[16:19],a[200:203],a[64:67]
ds_read_b128 a[216:219], v11 offset:0
s_waitcnt lgkmcnt(3)
mf a[96:99],v[16:19],a[204:207],a[96:99]
pm v26,v117,v113,s50
s_waitcnt lgkmcnt(2)
mf a[128:131],v[16:19],a[208:211],a[128:131]
pm v27,v125,v121,s50
s_waitcnt lgkmcnt(1)
mf a[160:163],v[16:19],a[212:215],a[160:163]
pm v28,v101,v97,s51
mf a[4:7],v[20:23],a[192:195],a[4:7]
pm v29,v109,v105,s51
mf a[36:39],v[20:23],a[196:199],a[36:39]
buffer_load_dwordx4 v[76:79], v1, s[12:15], s38 offen
mf a[68:71],v[20:23],a[200:203],a[68:71]
ds_read_b128 a[220:223], v11 offset:4096
mf a[100:103],v[20:23],a[204:207],a[100:103]
pm v30,v117,v113,s51
mf a[132:135],v[20:23],a[208:211],a[132:135]
pm v31,v125,v121,s51
mf a[164:167],v[20:23],a[212:215],a[164:167]
mf a[8:11],v[24:27],a[192:195],a[8:11]
pm v16,v102,v98,s50
pm v17,v110,v106,s50
mf a[40:43],v[24:27],a[196:199],a[40:43]
buffer_load_dwordx4 v[80:83], v1, s[12:15], s39 offen
mf a[72:75],v[24:27],a[200:203],a[72:75]
ds_read_b128 a[224:227], v11 offset:8192
mf a[104:107],v[24:27],a[204:207],a[104:107]
pm v18,v118,v114,s50
mf a[136:139],v[24:27],a[208:211],a[136:139]
pm v19,v126,v122,s50
mf a[168:171],v[24:27],a[212:215],a[168:171]
pm v20,v102,v98,s51
mf a[12:15],v[28:31],a[192:195],a[12:15]
pm v21,v110,v106,s51
mf a[44:47],v[28:31],a[196:199],a[44:47]
buffer_load_dwordx4 v[84:87], v1, s[12:15], s40 offen
mf a[76:79],v[28:31],a[200:203],a[76:79]
ds_read_b128 a[228:231], v11 offset:12288
mf a[108:111],v[28:31],a[204:207],a[108:111]
pm v22,v118,v114,s51
mf a[140:143],v[28:31],a[208:211],a[140:143]
pm v23,v126,v122,s51
mf a[172:175],v[28:31],a[212:215],a[172:175]
mf a[16:19],v[16:19],a[192:195],a[16:19]
pm v24,v103,v99,s50
pm v25,v111,v107,s50
mf a[48:51],v[16:19],a[196:199],a[48:51]
buffer_load_dwordx4 v[88:91], v1, s[12:15], s41 offen
mf a[80:83],v[16:19],a[200:203],a[80:83]
ds_read_b128 a[232:235], v11 offset:16384
mf a[112:115],v[16:19],a[204:207],a[112:115]
pm v26,v119,v115,s50
mf a[144:147],v[16:19],a[208:211],a[144:147]
pm v27,v127,v123,s50
mf a[176:179],v[16:19],a[212:215],a[176:179]
pm v28,v103,v99,s51
mf a[20:23],v[20:23],a[192:195],a[20:23]
pm v29,v111,v107,s51
mf a[52:55],v[20:23],a[196:199],a[52:55]
buffer_load_dwordx4 v[92:95], v1, s[12:15], s42 offen
mf a[84:87],v[20:23],a[200:203],a[84:87]
ds_read_b128 a[236:239], v11 offset:20480
mf a[116:119],v[20:23],a[204:207],a[116:119]
pm v30,v119,v115,s51
mf a[148:151],v[20:23],a[208:211],a[148:151]
pm v31,v127,v123,s51
mf a[180:183],v[20:23],a[212:215],a[180:183]
mf a[24:27],v[24:27],a[192:195],a[24:27]
s_waitcnt vmcnt(22)
pm v16,v132,v128,s50
s_add_u32 s100, s35, s86
mf a[56:59],v[24:27],a[196:199],a[56:59]
v_add_u32 v1, s100, v0
mf a[88:91],v[24:27],a[200:203],a[88:91]
buffer_load_dwordx4 v[96:99], v1, s[12:15], 0 offen
mf a[120:123],v[24:27],a[204:207],a[120:123]
s_waitcnt vmcnt(21)
pm v17,v140,v136,s50
s_waitcnt vmcnt(19)
pm v18,v148,v144,s50
mf a[152:155],v[24:27],a[208:211],a[152:155]
s_waitcnt vmcnt(17)
pm v19,v156,v152,s50
mf a[184:187],v[24:27],a[212:215],a[184:187]
s_add_u32 m0, s55, 0
mf a[28:31],v[28:31],a[192:195],a[28:31]
buffer_load_dwordx4 v4, s[20:23], 0 offen nt lds
mf a[60:63],v[28:31],a[196:199],a[60:63]
pm v20,v132,v128,s51
pm v21,v140,v136,s51
mf a[92:95],v[28:31],a[200:203],a[92:95]
pm v22,v148,v144,s51
mf a[124:127],v[28:31],a[204:207],a[124:127]
buffer_load_dwordx4 v[100:103], v1, s[12:15], s36 offen
mf a[156:159],v[28:31],a[208:211],a[156:159]
pm v23,v156,v152,s51
mf a[188:191],v[28:31],a[212:215],a[188:191]
s_barrier
s_waitcnt lgkmcnt(5)
mf a[0:3],v[16:19],a[216:219],a[0:3]
pm v24,v133,v129,s50
pm v25,v141,v137,s50
s_waitcnt lgkmcnt(4)
mf a[32:35],v[16:19],a[220:223],a[32:35]
buffer_load_dwordx4 v[104:107], v1, s[12:15], s37 offen
s_waitcnt lgkmcnt(3)
mf a[64:67],v[16:19],a[224:227],a[64:67]
ds_read_b128 a[192:195], v8 offset:24576
s_waitcnt lgkmcnt(3)
mf a[96:99],v[16:19],a[228:231],a[96:99]
pm v26,v149,v145,s50
s_waitcnt lgkmcnt(2)
mf a[128:131],v[16:19],a[232:235],a[128:131]
pm v27,v157,v153,s50
s_waitcnt lgkmcnt(1)
mf a[160:163],v[16:19],a[236:239],a[160:163]
pm v28,v133,v129,s51
mf a[4:7],v[20:23],a[216:219],a[4:7]
pm v29,v141,v137,s51
mf a[36:39],v[20:23],a[220:223],a[36:39]
buffer_load_dwordx4 v[108:111], v1, s[12:15], s38 offen
mf a[68:71],v[20:23],a[224:227],a[68:71]
ds_read_b128 a[196:199], v8 offset:28672
mf a[100:103],v[20:23],a[228:231],a[100:103]
pm v30,v149,v145,s51
mf a[132:135],v[20:23],a[232:235],a[132:135]
pm v31,v157,v153,s51
mf a[164:167],v[20:23],a[236:239],a[164:167]
mf a[8:11],v[24:27],a[216:219],a[8:11]
pm v16,v134,v130,s50
buffer_load_dwordx4 v[112:115], v1, s[12:15], s39 offen
mf a[40:43],v[24:27],a[220:223],a[40:43]
pm v17,v142,v138,s50
mf a[72:75],v[24:27],a[224:227],a[72:75]
ds_read_b128 a[200:203], v8 offset:32768
mf a[104:107],v[24:27],a[228:231],a[104:107]
pm v18,v150,v146,s50
mf a[136:139],v[24:27],a[232:235],a[136:139]
pm v19,v158,v154,s50
mf a[168:171],v[24:27],a[236:239],a[168:171]
buffer_load_dwordx4 v4, s[20:23], 0 offen offset:1024 nt lds
pm v20,v134,v130,s51
mf a[12:15],v[28:31],a[216:219],a[12:15]
pm v21,v142,v138,s51
mf a[44:47],v[28:31],a[220:223],a[44:47]
ds_read_b128 a[204:207], v8 offset:36864
mf a[76:79],v[28:31],a[224:227],a[76:79]
pm v22,v150,v146,s51
mf a[108:111],v[28:31],a[228:231],a[108:111]
buffer_load_dwordx4 v[116:119], v1, s[12:15], s40 offen
mf a[140:143],v[28:31],a[232:235],a[140:143]
pm v23,v158,v154,s51
mf a[172:175],v[28:31],a[236:239],a[172:175]
mf a[16:19],v[16:19],a[216:219],a[16:19]
pm v24,v135,v131,s50
pm v25,v143,v139,s50
mf a[48:51],v[16:19],a[220:223],a[48:51]
buffer_load_dwordx4 v[120:123], v1, s[12:15], s41 offen
mf a[80:83],v[16:19],a[224:227],a[80:83]
ds_read_b128 a[208:211], v8 offset:40960
mf a[112:115],v[16:19],a[228:231],a[112:115]
pm v26,v151,v147,s50
mf a[144:147],v[16:19],a[232:235],a[144:147]
pm v27,v159,v155,s50
mf a[176:179],v[16:19],a[236:239],a[176:179]
pm v28,v135,v131,s51
mf a[20:23],v[20:23],a[216:219],a[20:23]
pm v29,v143,v139,s51
mf a[52:55],v[20:23],a[220:223],a[52:55]
buffer_load_dwordx4 v[124:127], v1, s[12:15], s42 offen
mf a[84:87],v[20:23],a[224:227],a[84:87]
ds_read_b128 a[212:215], v8 offset:45056
mf a[116:119],v[20:23],a[228:231],a[116:119]
pm v30,v151,v147,s51
mf a[148:151],v[20:23],a[232:235],a[148:151]
pm v31,v159,v155,s51
mf a[180:183],v[20:23],a[236:239],a[180:183]
mf a[24:27],v[24:27],a[216:219],a[24:27]
s_waitcnt vmcnt(24)
pm v16,v36,v32,s50
s_add_u32 s100, s35, s87
mf a[56:59],v[24:27],a[220:223],a[56:59]
v_add_u32 v1, s100, v0
mf a[88:91],v[24:27],a[224:227],a[88:91]
buffer_load_dwordx4 v[128:131], v1, s[12:15], 0 offen
mf a[120:123],v[24:27],a[228:231],a[120:123]
s_waitcnt vmcnt(23)
pm v17,v44,v40,s50
mf a[152:155],v[24:27],a[232:235],a[152:155]
s_waitcnt vmcnt(21)
pm v18,v52,v48,s50
mf a[184:187],v[24:27],a[236:239],a[184:187]
s_waitcnt vmcnt(19)
pm v19,v60,v56,s50
buffer_load_dwordx4 v5, s[20:23], 0 offen offset:2048 nt lds
mf a[28:31],v[28:31],a[216:219],a[28:31]
pm v20,v36,v32,s51
mf a[60:63],v[28:31],a[220:223],a[60:63]
pm v21,v44,v40,s51
mf a[92:95],v[28:31],a[224:227],a[92:95]
pm v22,v52,v48,s51
mf a[124:127],v[28:31],a[228:231],a[124:127]
buffer_load_dwordx4 v[132:135], v1, s[12:15], s36 offen
mf a[156:159],v[28:31],a[232:235],a[156:159]
pm v23,v60,v56,s51
mf a[188:191],v[28:31],a[236:239],a[188:191]
s_waitcnt lgkmcnt(5)
mf a[0:3],v[16:19],a[192:195],a[0:3]
pm v24,v37,v33,s50
pm v25,v45,v41,s50
s_waitcnt lgkmcnt(4)
mf a[32:35],v[16:19],a[196:199],a[32:35]
buffer_load_dwordx4 v[136:139], v1, s[12:15], s37 offen
s_waitcnt lgkmcnt(3)
mf a[64:67],v[16:19],a[200:203],a[64:67]
ds_read_b128 a[216:219], v9 offset:24576
s_waitcnt lgkmcnt(3)
mf a[96:99],v[16:19],a[204:207],a[96:99]
pm v26,v53,v49,s50
s_waitcnt lgkmcnt(2)
mf a[128:131],v[16:19],a[208:211],a[128:131]
pm v27,v61,v57,s50
s_waitcnt lgkmcnt(1)
mf a[160:163],v[16:19],a[212:215],a[160:163]
pm v28,v37,v33,s51
mf a[4:7],v[20:23],a[192:195],a[4:7]
pm v29,v45,v41,s51
mf a[36:39],v[20:23],a[196:199],a[36:39]
buffer_load_dwordx4 v[140:143], v1, s[12:15], s38 offen
mf a[68:71],v[20:23],a[200:203],a[68:71]
ds_read_b128 a[220:223], v9 offset:28672
mf a[100:103],v[20:23],a[204:207],a[100:103]
pm v30,v53,v49,s51
mf a[132:135],v[20:23],a[208:211],a[132:135]
pm v31,v61,v57,s51
mf a[164:167],v[20:23],a[212:215],a[164:167]
mf a[8:11],v[24:27],a[192:195],a[8:11]
pm v16,v38,v34,s50
buffer_load_dwordx4 v[144:147], v1, s[12:15], s39 offen
mf a[40:43],v[24:27],a[196:199],a[40:43]
pm v17,v46,v42,s50
mf a[72:75],v[24:27],a[200:203],a[72:75]
ds_read_b128 a[224:227], v9 offset:32768
mf a[104:107],v[24:27],a[204:207],a[104:107]
pm v18,v54,v50,s50
mf a[136:139],v[24:27],a[208:211],a[136:139]
pm v19,v62,v58,s50
mf a[168:171],v[24:27],a[212:215],a[168:171]
buffer_load_dwordx4 v5, s[20:23], 0 offen offset:3072 nt lds
pm v20,v38,v34,s51
mf a[12:15],v[28:31],a[192:195],a[12:15]
pm v21,v46,v42,s51
mf a[44:47],v[28:31],a[196:199],a[44:47]
ds_read_b128 a[228:231], v9 offset:36864
mf a[76:79],v[28:31],a[200:203],a[76:79]
pm v22,v54,v50,s51
mf a[108:111],v[28:31],a[204:207],a[108:111]
buffer_load_dwordx4 v[148:151], v1, s[12:15], s40 offen
mf a[140:143],v[28:31],a[208:211],a[140:143]
pm v23,v62,v58,s51
mf a[172:175],v[28:31],a[212:215],a[172:175]
mf a[16:19],v[16:19],a[192:195],a[16:19]
pm v24,v39,v35,s50
buffer_load_dwordx4 v[152:155], v1, s[12:15], s41 offen
mf a[48:51],v[16:19],a[196:199],a[48:51]
pm v25,v47,v43,s50
mf a[80:83],v[16:19],a[200:203],a[80:83]
ds_read_b128 a[232:235], v9 offset:40960
mf a[112:115],v[16:19],a[204:207],a[112:115]
pm v26,v55,v51,s50
pm v27,v63,v59,s50
mf a[144:147],v[16:19],a[208:211],a[144:147]
s_add_u32 m0, s55, 4096
mf a[176:179],v[16:19],a[212:215],a[176:179]
buffer_load_dwordx4 v4, s[20:23], s43 offen nt lds
mf a[20:23],v[20:23],a[192:195],a[20:23]
pm v28,v39,v35,s51
mf a[52:55],v[20:23],a[196:199],a[52:55]
pm v29,v47,v43,s51
ds_read_b128 a[236:239], v9 offset:45056
mf a[84:87],v[20:23],a[200:203],a[84:87]
pm v30,v55,v51,s51
mf a[116:119],v[20:23],a[204:207],a[116:119]
buffer_load_dwordx4 v[156:159], v1, s[12:15], s42 offen
mf a[148:151],v[20:23],a[208:211],a[148:151]
pm v31,v63,v59,s51
mf a[180:183],v[20:23],a[212:215],a[180:183]
mf a[24:27],v[24:27],a[192:195],a[24:27]
s_waitcnt vmcnt(27)
pm v16,v68,v64,s50
mf a[56:59],v[24:27],a[196:199],a[56:59]
s_waitcnt vmcnt(25)
pm v17,v76,v72,s50
mf a[88:91],v[24:27],a[200:203],a[88:91]
s_waitcnt vmcnt(23)
pm v18,v84,v80,s50
mf a[120:123],v[24:27],a[204:207],a[120:123]
s_waitcnt vmcnt(21)
pm v19,v92,v88,s50
mf a[152:155],v[24:27],a[208:211],a[152:155]
buffer_load_dwordx4 v4, s[20:23], s43 offen offset:1024 nt lds
mf a[184:187],v[24:27],a[212:215],a[184:187]
mf a[28:31],v[28:31],a[192:195],a[28:31]
pm v20,v68,v64,s51
mf a[60:63],v[28:31],a[196:199],a[60:63]
pm v21,v76,v72,s51
mf a[92:95],v[28:31],a[200:203],a[92:95]
pm v22,v84,v80,s51
mf a[124:127],v[28:31],a[204:207],a[124:127]
pm v23,v92,v88,s51
mf a[156:159],v[28:31],a[208:211],a[156:159]
mf a[188:191],v[28:31],a[212:215],a[188:191]
s_waitcnt lgkmcnt(5)
mf a[0:3],v[16:19],a[216:219],a[0:3]
pm v24,v69,v65,s50
s_waitcnt lgkmcnt(4)
mf a[32:35],v[16:19],a[220:223],a[32:35]
pm v25,v77,v73,s50
s_waitcnt lgkmcnt(3)
mf a[64:67],v[16:19],a[224:227],a[64:67]
ds_read_b128 a[192:195], v10 offset:24576
s_waitcnt lgkmcnt(3)
mf a[96:99],v[16:19],a[228:231],a[96:99]
pm v26,v85,v81,s50
s_waitcnt lgkmcnt(2)
mf a[128:131],v[16:19],a[232:235],a[128:131]
pm v27,v93,v89,s50
s_waitcnt lgkmcnt(1)
mf a[160:163],v[16:19],a[236:239],a[160:163]
pm v28,v69,v65,s51
mf a[4:7],v[20:23],a[216:219],a[4:7]
pm v29,v77,v73,s51
mf a[36:39],v[20:23],a[220:223],a[36:39]
ds_read_b128 a[196:199], v10 offset:28672
mf a[68:71],v[20:23],a[224:227],a[68:71]
pm v30,v85,v81,s51
mf a[100:103],v[20:23],a[228:231],a[100:103]
pm v31,v93,v89,s51
mf a[132:135],v[20:23],a[232:235],a[132:135]
mf a[164:167],v[20:23],a[236:239],a[164:167]
mf a[8:11],v[24:27],a[216:219],a[8:11]
pm v16,v70,v66,s50
mf a[40:43],v[24:27],a[220:223],a[40:43]
pm v17,v78,v74,s50
mf a[72:75],v[24:27],a[224:227],a[72:75]
ds_read_b128 a[200:203], v10 offset:32768
mf a[104:107],v[24:27],a[228:231],a[104:107]
pm v18,v86,v82,s50
mf a[136:139],v[24:27],a[232:235],a[136:139]
pm v19,v94,v90,s50
mf a[168:171],v[24:27],a[236:239],a[168:171]
buffer_load_dwordx4 v5, s[20:23], s43 offen offset:2048 nt lds
mf a[12:15],v[28:31],a[216:219],a[12:15]
pm v20,v70,v66,s51
mf a[44:47],v[28:31],a[220:223],a[44:47]
pm v21,v78,v74,s51
mf a[76:79],v[28:31],a[224:227],a[76:79]
ds_read_b128 a[204:207], v10 offset:36864
mf a[108:111],v[28:31],a[228:231],a[108:111]
pm v22,v86,v82,s51
mf a[140:143],v[28:31],a[232:235],a[140:143]
pm v23,v94,v90,s51
mf a[172:175],v[28:31],a[236:239],a[172:175]
mf a[16:19],v[16:19],a[216:219],a[16:19]
pm v24,v71,v67,s50
mf a[48:51],v[16:19],a[220:223],a[48:51]
pm v25,v79,v75,s50
mf a[80:83],v[16:19],a[224:227],a[80:83]
ds_read_b128 a[208:211], v10 offset:40960
mf a[112:115],v[16:19],a[228:231],a[112:115]
pm v26,v87,v83,s50
mf a[144:147],v[16:19],a[232:235],a[144:147]
pm v27,v95,v91,s50
mf a[176:179],v[16:19],a[236:239],a[176:179]
buffer_load_dwordx4 v5, s[20:23], s43 offen offset:3072 nt lds
mf a[20:23],v[20:23],a[216:219],a[20:23]
pm v28,v71,v67,s51
mf a[52:55],v[20:23],a[220:223],a[52:55]
pm v29,v79,v75,s51
mf a[84:87],v[20:23],a[224:227],a[84:87]
ds_read_b128 a[212:215], v10 offset:45056
mf a[116:119],v[20:23],a[228:231],a[116:119]
pm v30,v87,v83,s51
mf a[148:151],v[20:23],a[232:235],a[148:151]
pm v31,v95,v91,s51
mf a[180:183],v[20:23],a[236:239],a[180:183]
mf a[24:27],v[24:27],a[216:219],a[24:27]
s_waitcnt vmcnt(21)
pm v16,v100,v96,s50
mf a[56:59],v[24:27],a[220:223],a[56:59]
s_waitcnt vmcnt(19)
pm v17,v108,v104,s50
mf a[88:91],v[24:27],a[224:227],a[88:91]
s_waitcnt vmcnt(16)
pm v18,v116,v112,s50
mf a[120:123],v[24:27],a[228:231],a[120:123]
s_waitcnt vmcnt(14)
pm v19,v124,v120,s50
mf a[152:155],v[24:27],a[232:235],a[152:155]
s_add_u32 m0, s55, 8192
mf a[184:187],v[24:27],a[236:239],a[184:187]
buffer_load_dwordx4 v4, s[20:23], s36 offen nt lds
mf a[28:31],v[28:31],a[216:219],a[28:31]
pm v20,v100,v96,s51
mf a[60:63],v[28:31],a[220:223],a[60:63]
pm v21,v108,v104,s51
mf a[92:95],v[28:31],a[224:227],a[92:95]
pm v22,v116,v112,s51
mf a[124:127],v[28:31],a[228:231],a[124:127]
pm v23,v124,v120,s51
mf a[156:159],v[28:31],a[232:235],a[156:159]
mf a[188:191],v[28:31],a[236:239],a[188:191]
s_waitcnt lgkmcnt(5)
mf a[0:3],v[16:19],a[192:195],a[0:3]
pm v24,v101,v97,s50
s_waitcnt lgkmcnt(4)
mf a[32:35],v[16:19],a[196:199],a[32:35]
pm v25,v109,v105,s50
s_waitcnt lgkmcnt(3)
mf a[64:67],v[16:19],a[200:203],a[64:67]
ds_read_b128 a[216:219], v11 offset:24576
s_waitcnt lgkmcnt(3)
mf a[96:99],v[16:19],a[204:207],a[96:99]
pm v26,v117,v113,s50
s_waitcnt lgkmcnt(2)
mf a[128:131],v[16:19],a[208:211],a[128:131]
pm v27,v125,v121,s50
s_waitcnt lgkmcnt(1)
mf a[160:163],v[16:19],a[212:215],a[160:163]
pm v28,v101,v97,s51
mf a[4:7],v[20:23],a[192:195],a[4:7]
pm v29,v109,v105,s51
mf a[36:39],v[20:23],a[196:199],a[36:39]
ds_read_b128 a[220:223], v11 offset:28672
mf a[68:71],v[20:23],a[200:203],a[68:71]
pm v30,v117,v113,s51
mf a[100:103],v[20:23],a[204:207],a[100:103]
pm v31,v125,v121,s51
mf a[132:135],v[20:23],a[208:211],a[132:135]
mf a[164:167],v[20:23],a[212:215],a[164:167]
mf a[8:11],v[24:27],a[192:195],a[8:11]
pm v16,v102,v98,s50
mf a[40:43],v[24:27],a[196:199],a[40:43]
pm v17,v110,v106,s50
mf a[72:75],v[24:27],a[200:203],a[72:75]
ds_read_b128 a[224:227], v11 offset:32768
mf a[104:107],v[24:27],a[204:207],a[104:107]
pm v18,v118,v114,s50
mf a[136:139],v[24:27],a[208:211],a[136:139]
pm v19,v126,v122,s50
mf a[168:171],v[24:27],a[212:215],a[168:171]
buffer_load_dwordx4 v4, s[20:23], s36 offen offset:1024 nt lds
mf a[12:15],v[28:31],a[192:195],a[12:15]
pm v20,v102,v98,s51
mf a[44:47],v[28:31],a[196:199],a[44:47]
pm v21,v110,v106,s51
mf a[76:79],v[28:31],a[200:203],a[76:79]
ds_read_b128 a[228:231], v11 offset:36864
mf a[108:111],v[28:31],a[204:207],a[108:111]
pm v22,v118,v114,s51
mf a[140:143],v[28:31],a[208:211],a[140:143]
pm v23,v126,v122,s51
mf a[172:175],v[28:31],a[212:215],a[172:175]
mf a[16:19],v[16:19],a[192:195],a[16:19]
pm v24,v103,v99,s50
mf a[48:51],v[16:19],a[196:199],a[48:51]
pm v25,v111,v107,s50
mf a[80:83],v[16:19],a[200:203],a[80:83]
ds_read_b128 a[232:235], v11 offset:40960
mf a[112:115],v[16:19],a[204:207],a[112:115]
pm v26,v119,v115,s50
mf a[144:147],v[16:19],a[208:211],a[144:147]
pm v27,v127,v123,s50
mf a[176:179],v[16:19],a[212:215],a[176:179]
buffer_load_dwordx4 v5, s[20:23], s36 offen offset:2048 nt lds
mf a[20:23],v[20:23],a[192:195],a[20:23]
pm v28,v103,v99,s51
mf a[52:55],v[20:23],a[196:199],a[52:55]
pm v29,v111,v107,s51
mf a[84:87],v[20:23],a[200:203],a[84:87]
ds_read_b128 a[236:239], v11 offset:45056
mf a[116:119],v[20:23],a[204:207],a[116:119]
pm v30,v119,v115,s51
mf a[148:151],v[20:23],a[208:211],a[148:151]
pm v31,v127,v123,s51
mf a[180:183],v[20:23],a[212:215],a[180:183]
mf a[24:27],v[24:27],a[192:195],a[24:27]
s_waitcnt vmcnt(14)
pm v16,v132,v128,s50
mf a[56:59],v[24:27],a[196:199],a[56:59]
s_waitcnt vmcnt(12)
pm v17,v140,v136,s50
mf a[88:91],v[24:27],a[200:203],a[88:91]
s_waitcnt vmcnt(9)
pm v18,v148,v144,s50
mf a[120:123],v[24:27],a[204:207],a[120:123]
s_waitcnt vmcnt(6)
pm v19,v156,v152,s50
mf a[152:155],v[24:27],a[208:211],a[152:155]
buffer_load_dwordx4 v5, s[20:23], s36 offen offset:3072 nt lds
mf a[184:187],v[24:27],a[212:215],a[184:187]
mf a[28:31],v[28:31],a[192:195],a[28:31]
pm v20,v132,v128,s51
mf a[60:63],v[28:31],a[196:199],a[60:63]
pm v21,v140,v136,s51
mf a[92:95],v[28:31],a[200:203],a[92:95]
pm v22,v148,v144,s51
mf a[124:127],v[28:31],a[204:207],a[124:127]
pm v23,v156,v152,s51
mf a[156:159],v[28:31],a[208:211],a[156:159]
mf a[188:191],v[28:31],a[212:215],a[188:191]
s_waitcnt lgkmcnt(0)
s_barrier
mf a[0:3],v[16:19],a[216:219],a[0:3]
buffer_load_dwordx4 v[160:163], v6, s[24:27], 0 offen nt
pm v216,v133,v129,s50
mf a[4:7],v[20:23],a[216:219],a[4:7]
pm v217,v141,v137,s50
pm v218,v149,v145,s50
mf a[32:35],v[16:19],a[220:223],a[32:35]
pm v219,v157,v153,s50
pm v220,v133,v129,s51
mf a[36:39],v[20:23],a[220:223],a[36:39]
pm v221,v141,v137,s51
pm v222,v149,v145,s51
mf a[8:11],v[216:219],a[216:219],a[8:11]
pm v223,v157,v153,s51
pm v224,v134,v130,s50
mf a[40:43],v[216:219],a[220:223],a[40:43]
pm v225,v142,v138,s50
pm v226,v150,v146,s50
mf a[12:15],v[220:223],a[216:219],a[12:15]
pm v227,v158,v154,s50
pm v228,v134,v130,s51
mf a[44:47],v[220:223],a[220:223],a[44:47]
pm v229,v142,v138,s51
pm v230,v150,v146,s51
mf a[16:19],v[224:227],a[216:219],a[16:19]
pm v231,v158,v154,s51
pm v232,v135,v131,s50
mf a[48:51],v[224:227],a[220:223],a[48:51]
pm v233,v143,v139,s50
pm v234,v151,v147,s50
mf a[20:23],v[228:231],a[216:219],a[20:23]
pm v235,v159,v155,s50
pm v236,v135,v131,s51
mf a[52:55],v[228:231],a[220:223],a[52:55]
pm v237,v143,v139,s51
pm v238,v151,v147,s51
mf a[24:27],v[232:235],a[216:219],a[24:27]
buffer_load_dwordx4 v[164:167], v6, s[24:27], 0 offen offset:256 nt
pm v239,v159,v155,s51
mf a[56:59],v[232:235],a[220:223],a[56:59]
ar v64,a0
ar v65,a4
mf a[28:31],v[236:239],a[216:219],a[28:31]
ar v66,a8
ar v67,a12
mf a[60:63],v[236:239],a[220:223],a[60:63]
ar v68,a16
ar v69,a20
mf a[64:67],v[16:19],a[224:227],a[64:67]
ar v70,a24
s_nop 0
ar v71,a28
mf a[68:71],v[20:23],a[224:227],a[68:71]
ar v72,a1
ar v73,a5
mf a[72:75],v[216:219],a[224:227],a[72:75]
ar v74,a9
ar v75,a13
mf a[76:79],v[220:223],a[224:227],a[76:79]
ar v76,a17
ar v77,a21
mf a[80:83],v[224:227],a[224:227],a[80:83]
ar v78,a25
ar v79,a29
mf a[84:87],v[228:231],a[224:227],a[84:87]
cv v80,v64,v65
cv v81,v66,v67
mf a[88:91],v[232:235],a[224:227],a[88:91]
cv v82,v68,v69
cv v83,v70,v71
mf a[92:95],v[236:239],a[224:227],a[92:95]
cv v84,v72,v73
cv v85,v74,v75
mf a[96:99],v[16:19],a[228:231],a[96:99]
cv v86,v76,v77
cv v87,v78,v79
mf a[100:103],v[20:23],a[228:231],a[100:103]
buffer_load_dwordx4 v[168:171], v6, s[24:27], 0 offen offset:512 nt
ar v64,a2
mf a[104:107],v[216:219],a[228:231],a[104:107]
ar v65,a6
ar v66,a10
mf a[108:111],v[220:223],a[228:231],a[108:111]
ar v67,a14
ar v68,a18
mf a[112:115],v[224:227],a[228:231],a[112:115]
ar v69,a22
ar v70,a26
mf a[116:119],v[228:231],a[228:231],a[116:119]
ar v71,a30
ar v72,a3
mf a[120:123],v[232:235],a[228:231],a[120:123]
ar v73,a7
ar v74,a11
mf a[124:127],v[236:239],a[228:231],a[124:127]
ar v75,a15
ar v76,a19
mf a[128:131],v[16:19],a[232:235],a[128:131]
ar v77,a23
ar v78,a27
mf a[132:135],v[20:23],a[232:235],a[132:135]
ar v79,a31
cv v88,v64,v65
mf a[136:139],v[216:219],a[232:235],a[136:139]
cv v89,v66,v67
cv v90,v68,v69
mf a[140:143],v[220:223],a[232:235],a[140:143]
cv v91,v70,v71
cv v92,v72,v73
mf a[144:147],v[224:227],a[232:235],a[144:147]
cv v93,v74,v75
cv v94,v76,v77
mf a[148:151],v[228:231],a[232:235],a[148:151]
buffer_load_dwordx4 v[172:175], v6, s[24:27], 0 offen offset:768 nt
cv v95,v78,v79
mf a[152:155],v[232:235],a[232:235],a[152:155]
ar v64,a32
ar v65,a36
mf a[156:159],v[236:239],a[232:235],a[156:159]
ar v66,a40
ar v67,a44
mf a[160:163],v[16:19],a[236:239],a[160:163]
ar v68,a48
ar v69,a52
mf a[164:167],v[20:23],a[236:239],a[164:167]
ar v70,a56
ar v71,a60
mf a[168:171],v[216:219],a[236:239],a[168:171]
ar v72,a33
ar v73,a37
mf a[172:175],v[220:223],a[236:239],a[172:175]
ar v74,a41
ar v75,a45
mf a[176:179],v[224:227],a[236:239],a[176:179]
ar v76,a49
ar v77,a53
mf a[180:183],v[228:231],a[236:239],a[180:183]
ar v78,a57
ar v79,a61
mf a[184:187],v[232:235],a[236:239],a[184:187]
v_add_u32 v3, s56, v14
ds_write_b128 v3, v[80:83] offset:0
mf a[188:191],v[236:239],a[236:239],a[188:191]
cv v96,v64,v65
cv v97,v66,v67
cv v98,v68,v69
cv v99,v70,v71
cv v100,v72,v73
cv v101,v74,v75
cv v102,v76,v77
cv v103,v78,v79
ar v64,a34
ar v65,a38
buffer_load_dwordx4 v[176:179], v6, s[24:27], s43 offen nt
ds_write_b128 v3, v[84:87] offset:3072
ar v66,a42
ar v67,a46
ar v68,a50
ar v69,a54
ar v70,a58
ar v71,a62
ar v72,a35
ar v73,a39
ar v74,a43
ar v75,a47
ar v76,a51
ar v77,a55
ar v78,a59
ds_write_b128 v3, v[88:91] offset:6144
ar v79,a63
cv v80,v64,v65
cv v81,v66,v67
cv v82,v68,v69
cv v83,v70,v71
cv v84,v72,v73
cv v85,v74,v75
cv v86,v76,v77
cv v87,v78,v79
ar v64,a64
ar v65,a68
ar v66,a72
ar v67,a76
ds_write_b128 v3, v[92:95] offset:9216
ar v68,a80
ar v69,a84
ar v70,a88
ar v71,a92
ar v72,a65
ar v73,a69
ar v74,a73
ar v75,a77
ar v76,a81
ar v77,a85
ar v78,a89
ar v79,a93
cv v88,v64,v65
ds_write_b128 v3, v[96:99] offset:1024
cv v89,v66,v67
cv v90,v68,v69
cv v91,v70,v71
cv v92,v72,v73
cv v93,v74,v75
cv v94,v76,v77
buffer_load_dwordx4 v[180:183], v6, s[24:27], s43 offen offset:256 nt
cv v95,v78,v79
ar v64,a66
ar v65,a70
ar v66,a74
ar v67,a78
ar v68,a82
ds_write_b128 v3, v[100:103] offset:4096
ar v69,a86
ar v70,a90
ar v71,a94
ar v72,a67
ar v73,a71
ar v74,a75
ar v75,a79
ar v76,a83
ar v77,a87
ar v78,a91
ar v79,a95
cv v96,v64,v65
cv v97,v66,v67
ds_write_b128 v3, v[80:83] offset:7168
cv v98,v68,v69
cv v99,v70,v71
cv v100,v72,v73
cv v101,v74,v75
cv v102,v76,v77
cv v103,v78,v79
ar v64,a96
ar v65,a100
ar v66,a104
ar v67,a108
ar v68,a112
ar v69,a116
ar v70,a120
ds_write_b128 v3, v[84:87] offset:10240
ar v71,a124
ar v72,a97
ar v73,a101
ar v74,a105
ar v75,a109
ar v76,a113
ar v77,a117
ar v78,a121
ar v79,a125
cv v80,v64,v65
cv v81,v66,v67
cv v82,v68,v69
cv v83,v70,v71
ds_write_b128 v3, v[88:91] offset:2048
buffer_load_dwordx4 v[184:187], v6, s[24:27], s43 offen offset:512 nt
cv v84,v72,v73
cv v85,v74,v75
cv v86,v76,v77
cv v87,v78,v79
ar v64,a98
ar v65,a102
ar v66,a106
ar v67,a110
ar v68,a114
ar v69,a118
ar v70,a122
ar v71,a126
ds_write_b128 v3, v[92:95] offset:5120
ar v72,a99
ar v73,a103
ar v74,a107
ar v75,a111
ar v76,a115
ar v77,a119
ar v78,a123
ar v79,a127
cv v88,v64,v65
cv v89,v66,v67
cv v90,v68,v69
cv v91,v70,v71
cv v92,v72,v73
ds_write_b128 v3, v[96:99] offset:8192
cv v93,v74,v75
cv v94,v76,v77
cv v95,v78,v79
ar v64,a128
ar v65,a132
ar v66,a136
ar v67,a140
ar v68,a144
ar v69,a148
ar v70,a152
ar v71,a156
ar v72,a129
ar v73,a133
ds_write_b128 v3, v[100:103] offset:11264
ar v74,a137
ar v75,a141
ar v76,a145
ar v77,a149
ar v78,a153
ar v79,a157
cv v96,v64,v65
cv v97,v66,v67
buffer_load_dwordx4 v[188:191], v6, s[24:27], s43 offen offset:768 nt
cv v98,v68,v69
cv v99,v70,v71
cv v100,v72,v73
cv v101,v74,v75
ds_write_b128 v3, v[80:83] offset:12288
cv v102,v76,v77
cv v103,v78,v79
ar v64,a130
ar v65,a134
ar v66,a138
ar v67,a142
ar v68,a146
ar v69,a150
ar v70,a154
ar v71,a158
ar v72,a131
ar v73,a135
ar v74,a139
ds_write_b128 v3, v[84:87] offset:15360
ar v75,a143
ar v76,a147
ar v77,a151
ar v78,a155
ar v79,a159
cv v80,v64,v65
cv v81,v66,v67
cv v82,v68,v69
cv v83,v70,v71
cv v84,v72,v73
cv v85,v74,v75
cv v86,v76,v77
cv v87,v78,v79
ds_write_b128 v3, v[88:91] offset:18432
ar v64,a160
ar v65,a164
ar v66,a168
ar v67,a172
ar v68,a176
ar v69,a180
ar v70,a184
ar v71,a188
ar v72,a161
ar v73,a165
ar v74,a169
ar v75,a173
ar v76,a177
ds_write_b128 v3, v[92:95] offset:21504
ar v77,a181
ar v78,a185
buffer_load_dwordx4 v[192:195], v6, s[24:27], s36 offen nt
ar v79,a189
cv v88,v64,v65
cv v89,v66,v67
cv v90,v68,v69
cv v91,v70,v71
s_lshr_b32 s59, s84, 12
cv v92,v72,v73
cv v93,v74,v75
cv v94,v76,v77
cv v95,v78,v79
ds_write_b128 v3, v[96:99] offset:13312
ar v64,a162
ar v65,a166
ar v66,a170
ar v67,a174
ar v68,a178
ar v69,a182
ar v70,a186
ar v71,a190
s_add_u32 s57, s56, 0xc000
v_xor_b32 v8, s59, v8
ar v72,a163
ar v73,a167
ar v74,a171
ds_write_b128 v3, v[100:103] offset:16384
ar v75,a175
ar v76,a179
ar v77,a183
ar v78,a187
ar v79,a191
cv v96,v64,v65
cv v97,v66,v67
cv v98,v68,v69
cv v99,v70,v71
v_add_u32 v8, s57, v8
cv v100,v72,v73
cv v101,v74,v75
cv v102,v76,v77
ds_write_b128 v3, v[80:83] offset:19456
cv v103,v78,v79
v_xor_b32 v9, 16, v8
v_xor_b32 v10, 32, v8
v_xor_b32 v11, 48, v8
buffer_load_dwordx4 v[196:199], v6, s[24:27], s36 offen offset:256 nt
ds_write_b128 v3, v[84:87] offset:22528
ds_write_b128 v3, v[88:91] offset:14336
ds_write_b128 v3, v[92:95] offset:17408
ds_write_b128 v3, v[96:99] offset:20480
buffer_load_dwordx4 v[200:203], v6, s[24:27], s36 offen offset:512 nt
ds_write_b128 v3, v[100:103] offset:23552
buffer_load_dwordx4 v[204:207], v6, s[24:27], s36 offen offset:768 nt
s_waitcnt lgkmcnt(0)
s_barrier
ds_read_b128 v[64:67], v14 offset:0
s_waitcnt vmcnt(12)
ds_read_b128 a[192:195], v8 offset:0
ds_read_b128 a[208:211], v8 offset:4096
ds_read_b128 a[224:227], v8 offset:8192
ds_read_b128 v[68:71], v14 offset:3072
ds_read_b128 a[196:199], v9 offset:0
ds_read_b128 a[212:215], v9 offset:4096
ds_read_b128 a[228:231], v9 offset:8192
ds_read_b128 v[72:75], v14 offset:6144
ds_read_b128 a[200:203], v10 offset:0
s_waitcnt lgkmcnt(8)
mf v[96:99],a[192:195],v[64:67],0
ds_read_b128 a[216:219], v10 offset:4096
s_waitcnt lgkmcnt(8)
mf v[100:103],a[208:211],v[64:67],0
ds_read_b128 a[232:235], v10 offset:8192
s_waitcnt lgkmcnt(8)
mf v[104:107],a[224:227],v[64:67],0
ds_read_b128 v[76:79], v14 offset:9216
s_add_u32 s100, s88, s90
v_add_u32 v2, s100, v15
s_waitcnt lgkmcnt(7)
mf v[96:99],a[196:199],v[68:71],v[96:99]
ds_read_b128 a[204:207], v11 offset:0
buffer_load_dwordx4 v[32:35], v2, s[16:19], 0 offen
s_waitcnt lgkmcnt(7)
mf v[100:103],a[212:215],v[68:71],v[100:103]
ds_read_b128 a[220:223], v11 offset:4096
s_add_u32 s100, s88, s91
s_waitcnt lgkmcnt(7)
mf v[104:107],a[228:231],v[68:71],v[104:107]
ds_read_b128 a[236:239], v11 offset:8192
ds_read_b128 v[80:83], v14 offset:1024
s_waitcnt lgkmcnt(7)
mf v[96:99],a[200:203],v[72:75],v[96:99]
ds_read_b128 v[84:87], v14 offset:4096
s_waitcnt lgkmcnt(7)
mf v[100:103],a[216:219],v[72:75],v[100:103]
ds_read_b128 v[88:91], v14 offset:7168
buffer_load_dwordx4 v[36:39], v2, s[16:19], 0 offen offset:1024
s_waitcnt lgkmcnt(7)
mf v[104:107],a[232:235],v[72:75],v[104:107]
ds_read_b128 v[92:95], v14 offset:10240
ds_read_b128 a[240:243], v14 offset:2048
ds_read_b128 a[244:247], v14 offset:5120
s_waitcnt lgkmcnt(8)
mf v[96:99],a[204:207],v[76:79],v[96:99]
ds_read_b128 a[248:251], v14 offset:8192
s_waitcnt lgkmcnt(8)
mf v[100:103],a[220:223],v[76:79],v[100:103]
buffer_load_dwordx4 v[40:43], v2, s[16:19], s36 offen
ds_read_b128 a[252:255], v14 offset:11264
s_waitcnt lgkmcnt(8)
mf v[104:107],a[236:239],v[76:79],v[104:107]
s_nop 0
v_max3_f32 v146, v96, v97, v98
s_waitcnt lgkmcnt(7)
mf v[108:111],a[192:195],v[80:83],0
v_max3_f32 v147, v99, v100, v101
v_max3_f32 v146, v146, v102, v103
mf v[112:115],a[208:211],v[80:83],0
s_nop 0
v_max3_f32 v147, v147, v104, v105
v_max3_f32 v146, v146, v106, v107
mf v[116:119],a[224:227],v[80:83],0
v_max_f32 v146, v146, v147
buffer_load_dwordx4 v[44:47], v2, s[16:19], s36 offen offset:1024
s_waitcnt lgkmcnt(6)
mf v[108:111],a[196:199],v[84:87],v[108:111]
v_mov_b32 v147, v146
s_waitcnt lgkmcnt(3)
mf v[120:123],a[192:195],a[240:243],0
v_permlane16_swap_b32 v146, v147
mf v[124:127],a[208:211],a[240:243],0
v_max_f32 v146, v146, v147
v_mov_b32 v147, v146
mf v[152:155],a[224:227],a[240:243],0
s_nop 0
v_permlane32_swap_b32 v146, v147
s_waitcnt lgkmcnt(2)
mf v[120:123],a[196:199],a[244:247],v[120:123]
buffer_load_dwordx4 v[48:51], v2, s[16:19], s37 offen
v_max_f32 v146, v146, v147
mf v[112:115],a[212:215],v[84:87],v[112:115]
v_mul_f32 v146, s52, v146
v_fma_f32 v96, v96, s52, -v146
mf v[124:127],a[212:215],a[244:247],v[124:127]
v_fma_f32 v97, v97, s52, -v146
v_fma_f32 v98, v98, s52, -v146
mf v[116:119],a[228:231],v[84:87],v[116:119]
v_fma_f32 v99, v99, s52, -v146
v_exp_f32 v96, v96
mf v[152:155],a[228:231],a[244:247],v[152:155]
buffer_load_dwordx4 v[52:55], v2, s[16:19], s37 offen offset:1024
v_exp_f32 v97, v97
mf v[108:111],a[200:203],v[88:91],v[108:111]
v_exp_f32 v98, v98
s_waitcnt lgkmcnt(1)
mf v[120:123],a[200:203],a[248:251],v[120:123]
v_exp_f32 v99, v99
mf v[112:115],a[216:219],v[88:91],v[112:115]
v_fma_f32 v100, v100, s52, -v146
v_fma_f32 v101, v101, s52, -v146
mf v[124:127],a[216:219],a[248:251],v[124:127]
buffer_load_dwordx4 v[56:59], v2, s[16:19], s38 offen
v_exp_f32 v100, v100
mf v[116:119],a[232:235],v[88:91],v[116:119]
v_exp_f32 v101, v101
mf v[152:155],a[232:235],a[248:251],v[152:155]
v_fma_f32 v102, v102, s52, -v146
v_fma_f32 v103, v103, s52, -v146
mf v[108:111],a[204:207],v[92:95],v[108:111]
v_fma_f32 v104, v104, s52, -v146
v_fma_f32 v105, v105, s52, -v146
s_waitcnt lgkmcnt(0)
mf v[120:123],a[204:207],a[252:255],v[120:123]
buffer_load_dwordx4 v[60:63], v2, s[16:19], s38 offen offset:1024
v_fma_f32 v106, v106, s52, -v146
mf v[112:115],a[220:223],v[92:95],v[112:115]
s_nop 0
v_max3_f32 v148, v108, v109, v110
v_fma_f32 v107, v107, s52, -v146
mf v[124:127],a[220:223],a[252:255],v[124:127]
s_nop 0
v_max3_f32 v150, v120, v121, v122
v_exp_f32 v102, v102
mf v[116:119],a[236:239],v[92:95],v[116:119]
v_max3_f32 v149, v111, v112, v113
v_max3_f32 v148, v148, v114, v115
mf v[152:155],a[236:239],a[252:255],v[152:155]
s_nop 0
v_max3_f32 v151, v123, v124, v125
v_max3_f32 v150, v150, v126, v127
v_exp_f32 v103, v103
s_nop 0
v_max3_f32 v149, v149, v116, v117
v_max3_f32 v148, v148, v118, v119
v_max_f32 v148, v148, v149
v_mov_b32 v149, v148
v_max3_f32 v151, v151, v152, v153
v_max3_f32 v150, v150, v154, v155
v_max_f32 v150, v150, v151
v_mov_b32 v151, v150
v_permlane16_swap_b32 v148, v149
v_add_f32 v146, v96, v97
v_permlane16_swap_b32 v150, v151
v_max_f32 v148, v148, v149
v_max_f32 v150, v150, v151
v_mov_b32 v149, v148
v_mov_b32 v151, v150
v_add_f32 v147, v98, v99
v_permlane32_swap_b32 v148, v149
v_permlane32_swap_b32 v150, v151
v_max_f32 v148, v148, v149
v_max_f32 v150, v150, v151
v_mul_f32 v148, s52, v148
v_mul_f32 v150, s52, v150
v_fma_f32 v108, v108, s52, -v148
v_fma_f32 v109, v109, s52, -v148
v_fma_f32 v110, v110, s52, -v148
v_fma_f32 v111, v111, s52, -v148
v_fma_f32 v120, v120, s52, -v150
v_fma_f32 v121, v121, s52, -v150
v_fma_f32 v122, v122, s52, -v150
v_fma_f32 v123, v123, s52, -v150
v_exp_f32 v108, v108
v_exp_f32 v109, v109
v_exp_f32 v110, v110
v_exp_f32 v111, v111
v_fma_f32 v112, v112, s52, -v148
v_fma_f32 v113, v113, s52, -v148
v_exp_f32 v120, v120
v_exp_f32 v121, v121
v_exp_f32 v122, v122
v_exp_f32 v123, v123
v_fma_f32 v124, v124, s52, -v150
v_fma_f32 v125, v125, s52, -v150
v_exp_f32 v112, v112
v_exp_f32 v113, v113
v_fma_f32 v114, v114, s52, -v148
v_fma_f32 v115, v115, s52, -v148
v_exp_f32 v124, v124
v_exp_f32 v125, v125
v_fma_f32 v126, v126, s52, -v150
v_fma_f32 v127, v127, s52, -v150
v_fma_f32 v116, v116, s52, -v148
v_fma_f32 v117, v117, s52, -v148
v_fma_f32 v118, v118, s52, -v148
v_fma_f32 v119, v119, s52, -v148
v_exp_f32 v114, v114
v_exp_f32 v115, v115
v_exp_f32 v104, v104
v_exp_f32 v105, v105
v_add_f32 v148, v108, v109
v_add_f32 v149, v110, v111
v_fma_f32 v152, v152, s52, -v150
v_fma_f32 v153, v153, s52, -v150
v_fma_f32 v154, v154, s52, -v150
v_fma_f32 v155, v155, s52, -v150
v_exp_f32 v126, v126
v_exp_f32 v127, v127
v_add_f32 v147, v147, v100
v_add_f32 v146, v146, v101
v_exp_f32 v116, v116
v_exp_f32 v117, v117
v_add_f32 v150, v120, v121
v_add_f32 v151, v122, v123
v_exp_f32 v106, v106
v_exp_f32 v107, v107
v_add_f32 v149, v149, v112
v_add_f32 v148, v148, v113
v_exp_f32 v152, v152
v_exp_f32 v153, v153
v_add_f32 v147, v147, v102
v_add_f32 v146, v146, v103
v_exp_f32 v118, v118
v_exp_f32 v119, v119
v_add_f32 v151, v151, v124
v_add_f32 v150, v150, v125
v_add_f32 v149, v149, v114
v_add_f32 v148, v148, v115
v_exp_f32 v154, v154
v_exp_f32 v155, v155
v_add_f32 v147, v147, v104
v_add_f32 v146, v146, v105
v_add_f32 v151, v151, v126
v_add_f32 v150, v150, v127
v_add_f32 v149, v149, v116
v_add_f32 v148, v148, v117
v_add_f32 v147, v147, v106
v_add_f32 v146, v146, v107
v_add_f32 v151, v151, v152
v_add_f32 v150, v150, v153
v_add_f32 v149, v149, v118
v_add_f32 v148, v148, v119
v_add_f32 v146, v146, v147
v_add_f32 v151, v151, v154
v_add_f32 v150, v150, v155
v_add_f32 v148, v148, v149
v_mov_b32 v147, v146
v_add_f32 v150, v150, v151
v_mov_b32 v149, v148
v_mov_b32 v151, v150
v_permlane16_swap_b32 v146, v147
v_permlane16_swap_b32 v148, v149
v_permlane16_swap_b32 v150, v151
v_add_f32 v146, v146, v147
v_add_f32 v148, v148, v149
v_mov_b32 v147, v146
v_add_f32 v150, v150, v151
v_mov_b32 v149, v148
v_mov_b32 v151, v150
v_permlane32_swap_b32 v146, v147
v_permlane32_swap_b32 v148, v149
v_permlane32_swap_b32 v150, v151
v_add_f32 v146, v146, v147
v_add_f32 v148, v148, v149
v_rcp_f32 v146, v146
v_add_f32 v150, v150, v151
v_rcp_f32 v148, v148
v_rcp_f32 v150, v150
v_mul_f32 v96, v96, v146
v_mul_f32 v97, v97, v146
v_mul_f32 v98, v98, v146
v_mul_f32 v99, v99, v146
v_mul_f32 v100, v100, v146
v_mul_f32 v101, v101, v146
v_mul_f32 v102, v102, v146
v_mul_f32 v103, v103, v146
v_mul_f32 v108, v108, v148
v_mul_f32 v109, v109, v148
v_mul_f32 v110, v110, v148
v_mul_f32 v111, v111, v148
v_mul_f32 v112, v112, v148
v_mul_f32 v113, v113, v148
v_mul_f32 v114, v114, v148
v_mul_f32 v115, v115, v148
cv v128,v96,v97
cv v129,v98,v99
cv v130,v100,v101
cv v131,v102,v103
v_mul_f32 v120, v120, v150
v_mul_f32 v121, v121, v150
v_mul_f32 v122, v122, v150
v_mul_f32 v123, v123, v150
v_mul_f32 v124, v124, v150
v_mul_f32 v125, v125, v150
v_mul_f32 v126, v126, v150
v_mul_f32 v127, v127, v150
cv v132,v108,v109
cv v133,v110,v111
cv v134,v112,v113
cv v135,v114,v115
cv v136,v120,v121
cv v137,v122,v123
cv v138,v124,v125
cv v139,v126,v127
v_mul_f32 v104, v104, v146
v_mul_f32 v105, v105, v146
v_mul_f32 v106, v106, v146
v_mul_f32 v107, v107, v146
v_mul_f32 v116, v116, v148
v_mul_f32 v117, v117, v148
v_mul_f32 v118, v118, v148
v_mul_f32 v119, v119, v148
cv v140,v104,v105
cv v141,v106,v107
v_mul_f32 v152, v152, v150
v_mul_f32 v153, v153, v150
v_mul_f32 v154, v154, v150
v_mul_f32 v155, v155, v150
cv v142,v116,v117
cv v143,v118,v119
cv v144,v152,v153
cv v145,v154,v155
v_add_u32 v2, s100, v15
buffer_load_dwordx4 v[64:67], v2, s[16:19], 0 offen
s_add_u32 m0, s55, 0
s_waitcnt vmcnt(19)
pm v208,v164,v160,s50
s_waitcnt vmcnt(17)
pm v209,v172,v168,s50
s_waitcnt vmcnt(15)
pm v210,v180,v176,s50
s_waitcnt vmcnt(13)
pm v211,v188,v184,s50
pm v212,v164,v160,s51
buffer_load_dwordx4 v[68:71], v2, s[16:19], 0 offen offset:1024
mf v[232:235],v[208:211],v[128:131],0
pm v213,v172,v168,s51
pm v214,v180,v176,s51
mf v[240:243],v[208:211],v[132:135],0
pm v215,v188,v184,s51
s_waitcnt vmcnt(12)
pm v216,v196,v192,s50
mf v[248:251],v[208:211],v[136:139],0
s_waitcnt vmcnt(10)
pm v217,v204,v200,s50
pm v218,v196,v192,s51
mf v[236:239],v[212:215],v[128:131],0
pm v219,v204,v200,s51
pm v220,v165,v161,s50
mf v[244:247],v[212:215],v[132:135],0
buffer_load_dwordx4 v[72:75], v2, s[16:19], s36 offen
pm v221,v173,v169,s50
mf v[252:255],v[212:215],v[136:139],0
pm v222,v181,v177,s50
pm v223,v189,v185,s50
v_mfma_f32_16x16x16_bf16 v[232:235], v[216:217], v[140:141], v[232:235]
pm v224,v165,v161,s51
pm v225,v173,v169,s51
v_mfma_f32_16x16x16_bf16 v[236:239], v[218:219], v[140:141], v[236:239]
pm v226,v181,v177,s51
pm v227,v189,v185,s51
v_mfma_f32_16x16x16_bf16 v[240:243], v[216:217], v[142:143], v[240:243]
pm v228,v197,v193,s50
buffer_load_dwordx4 v[76:79], v2, s[16:19], s36 offen offset:1024
v_mfma_f32_16x16x16_bf16 v[244:247], v[218:219], v[142:143], v[244:247]
s_nop 1
cv v16,v232,v236
cv v17,v233,v237
v_mfma_f32_16x16x16_bf16 v[248:251], v[216:217], v[144:145], v[248:251]
cv v18,v234,v238
cv v19,v235,v239
v_mfma_f32_16x16x16_bf16 v[252:255], v[218:219], v[144:145], v[252:255]
ds_write_b128 v14, v[16:19] offset:0
cv v20,v240,v244
mf v[232:235],v[220:223],v[128:131],0
cv v21,v241,v245
cv v22,v242,v246
mf v[236:239],v[224:227],v[128:131],0
buffer_load_dwordx4 v[80:83], v2, s[16:19], s37 offen
cv v23,v243,v247
mf v[240:243],v[220:223],v[132:135],0
cv v24,v248,v252
cv v25,v249,v253
mf v[244:247],v[224:227],v[132:135],0
ds_write_b128 v14, v[20:23] offset:1024
cv v26,v250,v254
cv v27,v251,v255
mf v[248:251],v[220:223],v[136:139],0
pm v229,v205,v201,s50
pm v230,v197,v193,s51
mf v[252:255],v[224:227],v[136:139],0
buffer_load_dwordx4 v[84:87], v2, s[16:19], s37 offen offset:1024
pm v231,v205,v201,s51
v_mfma_f32_16x16x16_bf16 v[232:235], v[228:229], v[140:141], v[232:235]
pm v208,v166,v162,s50
ds_write_b128 v14, v[24:27] offset:2048
v_mfma_f32_16x16x16_bf16 v[236:239], v[230:231], v[140:141], v[236:239]
pm v209,v174,v170,s50
pm v210,v182,v178,s50
v_mfma_f32_16x16x16_bf16 v[240:243], v[228:229], v[142:143], v[240:243]
pm v211,v190,v186,s50
pm v212,v166,v162,s51
v_mfma_f32_16x16x16_bf16 v[244:247], v[230:231], v[142:143], v[244:247]
pm v213,v174,v170,s51
buffer_load_dwordx4 v[88:91], v2, s[16:19], s38 offen
v_mfma_f32_16x16x16_bf16 v[248:251], v[228:229], v[144:145], v[248:251]
pm v214,v182,v178,s51
pm v215,v190,v186,s51
v_mfma_f32_16x16x16_bf16 v[252:255], v[230:231], v[144:145], v[252:255]
cv v28,v232,v236
cv v29,v233,v237
cv v30,v234,v238
cv v31,v235,v239
mf v[232:235],v[208:211],v[128:131],0
ds_write_b128 v14, v[28:31] offset:3072
cv v16,v240,v244
mf v[236:239],v[212:215],v[128:131],0
buffer_load_dwordx4 v[92:95], v2, s[16:19], s38 offen offset:1024
cv v17,v241,v245
cv v18,v242,v246
cv v19,v243,v247
mf v[240:243],v[208:211],v[132:135],0
cv v20,v248,v252
cv v21,v249,v253
mf v[244:247],v[212:215],v[132:135],0
ds_write_b128 v14, v[16:19] offset:4096
cv v22,v250,v254
cv v23,v251,v255
mf v[248:251],v[208:211],v[136:139],0
pm v216,v198,v194,s50
pm v217,v206,v202,s50
mf v[252:255],v[212:215],v[136:139],0
buffer_load_dwordx4 v4, s[20:23], s44 offen nt lds
pm v218,v198,v194,s51
v_mfma_f32_16x16x16_bf16 v[232:235], v[216:217], v[140:141], v[232:235]
pm v219,v206,v202,s51
ds_write_b128 v14, v[20:23] offset:5120
v_mfma_f32_16x16x16_bf16 v[240:243], v[216:217], v[142:143], v[240:243]
pm v220,v167,v163,s50
pm v221,v175,v171,s50
v_mfma_f32_16x16x16_bf16 v[236:239], v[218:219], v[140:141], v[236:239]
pm v222,v183,v179,s50
pm v223,v191,v187,s50
v_mfma_f32_16x16x16_bf16 v[244:247], v[218:219], v[142:143], v[244:247]
pm v224,v167,v163,s51
buffer_load_dwordx4 v4, s[20:23], s44 offen offset:1024 nt lds
v_mfma_f32_16x16x16_bf16 v[248:251], v[216:217], v[144:145], v[248:251]
pm v225,v175,v171,s51
pm v226,v183,v179,s51
v_mfma_f32_16x16x16_bf16 v[252:255], v[218:219], v[144:145], v[252:255]
pm v227,v191,v187,s51
cv v24,v232,v236
cv v25,v233,v237
cv v26,v234,v238
cv v27,v235,v239
mf v[232:235],v[220:223],v[128:131],0
ds_write_b128 v14, v[24:27] offset:6144
cv v28,v240,v244
mf v[236:239],v[224:227],v[128:131],0
buffer_load_dwordx4 v5, s[20:23], s44 offen offset:2048 nt lds
cv v29,v241,v245
cv v30,v242,v246
cv v31,v243,v247
mf v[240:243],v[220:223],v[132:135],0
cv v16,v248,v252
cv v17,v249,v253
mf v[244:247],v[224:227],v[132:135],0
ds_write_b128 v14, v[28:31] offset:7168
cv v18,v250,v254
cv v19,v251,v255
mf v[248:251],v[220:223],v[136:139],0
pm v228,v199,v195,s50
pm v229,v207,v203,s50
mf v[252:255],v[224:227],v[136:139],0
buffer_load_dwordx4 v5, s[20:23], s44 offen offset:3072 nt lds
pm v230,v199,v195,s51
v_mfma_f32_16x16x16_bf16 v[232:235], v[228:229], v[140:141], v[232:235]
pm v231,v207,v203,s51
ds_write_b128 v14, v[16:19] offset:8192
v_mfma_f32_16x16x16_bf16 v[240:243], v[228:229], v[142:143], v[240:243]
s_add_u32 m0, s55, 4096
v_mfma_f32_16x16x16_bf16 v[236:239], v[230:231], v[140:141], v[236:239]
v_mfma_f32_16x16x16_bf16 v[244:247], v[230:231], v[142:143], v[244:247]
buffer_load_dwordx4 v4, s[20:23], s45 offen nt lds
v_mfma_f32_16x16x16_bf16 v[248:251], v[228:229], v[144:145], v[248:251]
s_nop 4
cv v20,v232,v236
cv v21,v233,v237
v_mfma_f32_16x16x16_bf16 v[252:255], v[230:231], v[144:145], v[252:255]
cv v22,v234,v238
cv v23,v235,v239
ds_write_b128 v14, v[20:23] offset:9216
cv v24,v240,v244
cv v25,v241,v245
cv v26,v242,v246
cv v27,v243,v247
s_nop 0
cv v28,v248,v252
cv v29,v249,v253
buffer_load_dwordx4 v4, s[20:23], s45 offen offset:1024 nt lds
cv v30,v250,v254
cv v31,v251,v255
ds_write_b128 v14, v[24:27] offset:10240
ds_write_b128 v14, v[28:31] offset:11264
s_waitcnt lgkmcnt(0)
s_barrier
s_add_u32 s101, s94, s96
v_add_u32 v3, s101, v12
ds_read_b128 a[192:195], v3 offset:0
ds_read_b128 a[196:199], v3 offset:1024
ds_read_b128 a[200:203], v3 offset:2048
ds_read_b128 a[204:207], v3 offset:12288
ds_read_b128 a[208:211], v3 offset:13312
ds_read_b128 a[212:215], v3 offset:14336
s_waitcnt vmcnt(20)
pm v16,v36,v32,s50
s_waitcnt vmcnt(18)
pm v17,v44,v40,s50
s_waitcnt vmcnt(16)
pm v18,v52,v48,s50
s_waitcnt vmcnt(14)
pm v19,v60,v56,s50
pm v20,v36,v32,s51
pm v21,v44,v40,s51
pm v22,v52,v48,s51
pm v23,v60,v56,s51
s_waitcnt lgkmcnt(5)
mf a[0:3],a[192:195],v[16:19],0
pm v24,v37,v33,s50
s_add_u32 s100, s88, s92
s_waitcnt lgkmcnt(4)
mf a[32:35],a[196:199],v[16:19],0
v_add_u32 v2, s100, v15
buffer_load_dwordx4 v[96:99], v2, s[16:19], 0 offen
s_waitcnt lgkmcnt(3)
mf a[64:67],a[200:203],v[16:19],0
pm v25,v45,v41,s50
s_waitcnt lgkmcnt(2)
mf a[96:99],a[204:207],v[16:19],0
s_add_u32 s101, s94, s97
v_add_u32 v3, s101, v12
s_waitcnt lgkmcnt(1)
mf a[128:131],a[208:211],v[16:19],0
ds_read_b128 a[216:219], v3 offset:0
s_waitcnt lgkmcnt(1)
mf a[160:163],a[212:215],v[16:19],0
pm v26,v53,v49,s50
pm v27,v61,v57,s50
mf a[4:7],a[192:195],v[20:23],0
buffer_load_dwordx4 v[100:103], v2, s[16:19], 0 offen offset:1024
mf a[36:39],a[196:199],v[20:23],0
pm v28,v37,v33,s51
pm v29,v45,v41,s51
mf a[68:71],a[200:203],v[20:23],0
ds_read_b128 a[220:223], v3 offset:1024
mf a[100:103],a[204:207],v[20:23],0
pm v30,v53,v49,s51
buffer_load_dwordx4 v[104:107], v2, s[16:19], s36 offen
mf a[132:135],a[208:211],v[20:23],0
pm v31,v61,v57,s51
mf a[164:167],a[212:215],v[20:23],0
mf a[8:11],a[192:195],v[24:27],0
pm v16,v38,v34,s50
buffer_load_dwordx4 v[108:111], v2, s[16:19], s36 offen offset:1024
mf a[40:43],a[196:199],v[24:27],0
pm v17,v46,v42,s50
mf a[72:75],a[200:203],v[24:27],0
ds_read_b128 a[224:227], v3 offset:2048
mf a[104:107],a[204:207],v[24:27],0
pm v18,v54,v50,s50
mf a[136:139],a[208:211],v[24:27],0
pm v19,v62,v58,s50
mf a[168:171],a[212:215],v[24:27],0
buffer_load_dwordx4 v[112:115], v2, s[16:19], s37 offen
pm v20,v38,v34,s51
mf a[12:15],a[192:195],v[28:31],0
pm v21,v46,v42,s51
mf a[44:47],a[196:199],v[28:31],0
ds_read_b128 a[228:231], v3 offset:12288
mf a[76:79],a[200:203],v[28:31],0
pm v22,v54,v50,s51
mf a[108:111],a[204:207],v[28:31],0
buffer_load_dwordx4 v[116:119], v2, s[16:19], s37 offen offset:1024
mf a[140:143],a[208:211],v[28:31],0
pm v23,v62,v58,s51
mf a[172:175],a[212:215],v[28:31],0
mf a[16:19],a[192:195],v[16:19],0
pm v24,v39,v35,s50
buffer_load_dwordx4 v[120:123], v2, s[16:19], s38 offen
mf a[48:51],a[196:199],v[16:19],0
pm v25,v47,v43,s50
mf a[80:83],a[200:203],v[16:19],0
ds_read_b128 a[232:235], v3 offset:13312
pm v26,v55,v51,s50
mf a[112:115],a[204:207],v[16:19],0
pm v27,v63,v59,s50
mf a[144:147],a[208:211],v[16:19],0
buffer_load_dwordx4 v[124:127], v2, s[16:19], s38 offen offset:1024
mf a[176:179],a[212:215],v[16:19],0
pm v28,v39,v35,s51
pm v29,v47,v43,s51
mf a[20:23],a[192:195],v[20:23],0
ds_read_b128 a[236:239], v3 offset:14336
mf a[52:55],a[196:199],v[20:23],0
pm v30,v55,v51,s51
mf a[84:87],a[200:203],v[20:23],0
s_add_u32 s100, s88, s93
v_add_u32 v2, s100, v15
mf a[116:119],a[204:207],v[20:23],0
buffer_load_dwordx4 v[128:131], v2, s[16:19], 0 offen
mf a[148:151],a[208:211],v[20:23],0
pm v31,v63,v59,s51
mf a[180:183],a[212:215],v[20:23],0
mf a[24:27],a[192:195],v[24:27],0
s_waitcnt vmcnt(21)
pm v16,v68,v64,s50
mf a[56:59],a[196:199],v[24:27],0
buffer_load_dwordx4 v[132:135], v2, s[16:19], 0 offen offset:1024
mf a[88:91],a[200:203],v[24:27],0
s_waitcnt vmcnt(20)
pm v17,v76,v72,s50
mf a[120:123],a[204:207],v[24:27],0
s_waitcnt vmcnt(18)
pm v18,v84,v80,s50
mf a[152:155],a[208:211],v[24:27],0
s_waitcnt vmcnt(16)
pm v19,v92,v88,s50
mf a[184:187],a[212:215],v[24:27],0
buffer_load_dwordx4 v[136:139], v2, s[16:19], s36 offen
mf a[28:31],a[192:195],v[28:31],0
pm v20,v68,v64,s51
mf a[60:63],a[196:199],v[28:31],0
pm v21,v76,v72,s51
mf a[92:95],a[200:203],v[28:31],0
pm v22,v84,v80,s51
mf a[124:127],a[204:207],v[28:31],0
buffer_load_dwordx4 v[140:143], v2, s[16:19], s36 offen offset:1024
mf a[156:159],a[208:211],v[28:31],0
pm v23,v92,v88,s51
mf a[188:191],a[212:215],v[28:31],0
s_waitcnt lgkmcnt(5)
mf a[0:3],a[216:219],v[16:19],a[0:3]
pm v24,v69,v65,s50
buffer_load_dwordx4 v[144:147], v2, s[16:19], s37 offen
s_waitcnt lgkmcnt(4)
mf a[32:35],a[220:223],v[16:19],a[32:35]
pm v25,v77,v73,s50
s_waitcnt lgkmcnt(3)
mf a[64:67],a[224:227],v[16:19],a[64:67]
s_add_u32 s101, s94, s98
v_add_u32 v3, s101, v12
s_waitcnt lgkmcnt(2)
mf a[96:99],a[228:231],v[16:19],a[96:99]
ds_read_b128 a[192:195], v3 offset:0
s_waitcnt lgkmcnt(2)
mf a[128:131],a[232:235],v[16:19],a[128:131]
pm v26,v85,v81,s50
s_waitcnt lgkmcnt(1)
mf a[160:163],a[236:239],v[16:19],a[160:163]
pm v27,v93,v89,s50
buffer_load_dwordx4 v[148:151], v2, s[16:19], s37 offen offset:1024
mf a[4:7],a[216:219],v[20:23],a[4:7]
pm v28,v69,v65,s51
mf a[36:39],a[220:223],v[20:23],a[36:39]
pm v29,v77,v73,s51
mf a[68:71],a[224:227],v[20:23],a[68:71]
ds_read_b128 a[196:199], v3 offset:1024
pm v30,v85,v81,s51
mf a[100:103],a[228:231],v[20:23],a[100:103]
buffer_load_dwordx4 v[152:155], v2, s[16:19], s38 offen
mf a[132:135],a[232:235],v[20:23],a[132:135]
pm v31,v93,v89,s51
mf a[164:167],a[236:239],v[20:23],a[164:167]
mf a[8:11],a[216:219],v[24:27],a[8:11]
pm v16,v70,v66,s50
buffer_load_dwordx4 v[156:159], v2, s[16:19], s38 offen offset:1024
mf a[40:43],a[220:223],v[24:27],a[40:43]
pm v17,v78,v74,s50
mf a[72:75],a[224:227],v[24:27],a[72:75]
ds_read_b128 a[200:203], v3 offset:2048
pm v18,v86,v82,s50
mf a[104:107],a[228:231],v[24:27],a[104:107]
pm v19,v94,v90,s50
mf a[136:139],a[232:235],v[24:27],a[136:139]
s_add_u32 s100, s89, s90
mf a[168:171],a[236:239],v[24:27],a[168:171]
v_add_u32 v2, s100, v15
buffer_load_dwordx4 v[32:35], v2, s[16:19], 0 offen
mf a[12:15],a[216:219],v[28:31],a[12:15]
pm v20,v70,v66,s51
mf a[44:47],a[220:223],v[28:31],a[44:47]
pm v21,v78,v74,s51
mf a[76:79],a[224:227],v[28:31],a[76:79]
ds_read_b128 a[204:207], v3 offset:12288
pm v22,v86,v82,s51
mf a[108:111],a[228:231],v[28:31],a[108:111]
buffer_load_dwordx4 v[36:39], v2, s[16:19], 0 offen offset:1024
mf a[140:143],a[232:235],v[28:31],a[140:143]
pm v23,v94,v90,s51
mf a[172:175],a[236:239],v[28:31],a[172:175]
mf a[16:19],a[216:219],v[16:19],a[16:19]
pm v24,v71,v67,s50
buffer_load_dwordx4 v[40:43], v2, s[16:19], s36 offen
mf a[48:51],a[220:223],v[16:19],a[48:51]
pm v25,v79,v75,s50
mf a[80:83],a[224:227],v[16:19],a[80:83]
ds_read_b128 a[208:211], v3 offset:13312
mf a[112:115],a[228:231],v[16:19],a[112:115]
pm v26,v87,v83,s50
mf a[144:147],a[232:235],v[16:19],a[144:147]
pm v27,v95,v91,s50
mf a[176:179],a[236:239],v[16:19],a[176:179]
buffer_load_dwordx4 v[44:47], v2, s[16:19], s36 offen offset:1024
pm v28,v71,v67,s51
mf a[20:23],a[216:219],v[20:23],a[20:23]
pm v29,v79,v75,s51
mf a[52:55],a[220:223],v[20:23],a[52:55]
ds_read_b128 a[212:215], v3 offset:14336
mf a[84:87],a[224:227],v[20:23],a[84:87]
pm v30,v87,v83,s51
mf a[116:119],a[228:231],v[20:23],a[116:119]
buffer_load_dwordx4 v[48:51], v2, s[16:19], s37 offen
mf a[148:151],a[232:235],v[20:23],a[148:151]
pm v31,v95,v91,s51
mf a[180:183],a[236:239],v[20:23],a[180:183]
mf a[24:27],a[216:219],v[24:27],a[24:27]
s_waitcnt vmcnt(19)
pm v16,v100,v96,s50
mf a[56:59],a[220:223],v[24:27],a[56:59]
buffer_load_dwordx4 v[52:55], v2, s[16:19], s37 offen offset:1024
mf a[88:91],a[224:227],v[24:27],a[88:91]
s_waitcnt vmcnt(18)
pm v17,v108,v104,s50
mf a[120:123],a[228:231],v[24:27],a[120:123]
s_waitcnt vmcnt(16)
pm v18,v116,v112,s50
mf a[152:155],a[232:235],v[24:27],a[152:155]
s_waitcnt vmcnt(14)
pm v19,v124,v120,s50
mf a[184:187],a[236:239],v[24:27],a[184:187]
buffer_load_dwordx4 v[56:59], v2, s[16:19], s38 offen
mf a[28:31],a[216:219],v[28:31],a[28:31]
pm v20,v100,v96,s51
mf a[60:63],a[220:223],v[28:31],a[60:63]
pm v21,v108,v104,s51
mf a[92:95],a[224:227],v[28:31],a[92:95]
pm v22,v116,v112,s51
mf a[124:127],a[228:231],v[28:31],a[124:127]
buffer_load_dwordx4 v[60:63], v2, s[16:19], s38 offen offset:1024
mf a[156:159],a[232:235],v[28:31],a[156:159]
pm v23,v124,v120,s51
mf a[188:191],a[236:239],v[28:31],a[188:191]
s_waitcnt lgkmcnt(5)
mf a[0:3],a[192:195],v[16:19],a[0:3]
pm v24,v101,v97,s50
s_add_u32 s100, s89, s91
s_waitcnt lgkmcnt(4)
mf a[32:35],a[196:199],v[16:19],a[32:35]
v_add_u32 v2, s100, v15
buffer_load_dwordx4 v[64:67], v2, s[16:19], 0 offen
s_waitcnt lgkmcnt(3)
mf a[64:67],a[200:203],v[16:19],a[64:67]
pm v25,v109,v105,s50
s_waitcnt lgkmcnt(2)
mf a[96:99],a[204:207],v[16:19],a[96:99]
s_add_u32 s101, s94, s99
v_add_u32 v3, s101, v12
s_waitcnt lgkmcnt(1)
mf a[128:131],a[208:211],v[16:19],a[128:131]
ds_read_b128 a[216:219], v3 offset:0
s_waitcnt lgkmcnt(1)
mf a[160:163],a[212:215],v[16:19],a[160:163]
pm v26,v117,v113,s50
pm v27,v125,v121,s50
mf a[4:7],a[192:195],v[20:23],a[4:7]
buffer_load_dwordx4 v[68:71], v2, s[16:19], 0 offen offset:1024
mf a[36:39],a[196:199],v[20:23],a[36:39]
pm v28,v101,v97,s51
pm v29,v109,v105,s51
mf a[68:71],a[200:203],v[20:23],a[68:71]
ds_read_b128 a[220:223], v3 offset:1024
mf a[100:103],a[204:207],v[20:23],a[100:103]
pm v30,v117,v113,s51
buffer_load_dwordx4 v[72:75], v2, s[16:19], s36 offen
mf a[132:135],a[208:211],v[20:23],a[132:135]
pm v31,v125,v121,s51
mf a[164:167],a[212:215],v[20:23],a[164:167]
mf a[8:11],a[192:195],v[24:27],a[8:11]
pm v16,v102,v98,s50
buffer_load_dwordx4 v[76:79], v2, s[16:19], s36 offen offset:1024
mf a[40:43],a[196:199],v[24:27],a[40:43]
pm v17,v110,v106,s50
mf a[72:75],a[200:203],v[24:27],a[72:75]
ds_read_b128 a[224:227], v3 offset:2048
mf a[104:107],a[204:207],v[24:27],a[104:107]
pm v18,v118,v114,s50
buffer_load_dwordx4 v5, s[20:23], s45 offen offset:2048 nt lds
mf a[136:139],a[208:211],v[24:27],a[136:139]
pm v19,v126,v122,s50
mf a[168:171],a[212:215],v[24:27],a[168:171]
pm v20,v102,v98,s51
mf a[12:15],a[192:195],v[28:31],a[12:15]
buffer_load_dwordx4 v[80:83], v2, s[16:19], s37 offen
mf a[44:47],a[196:199],v[28:31],a[44:47]
pm v21,v110,v106,s51
ds_read_b128 a[228:231], v3 offset:12288
mf a[76:79],a[200:203],v[28:31],a[76:79]
pm v22,v118,v114,s51
mf a[108:111],a[204:207],v[28:31],a[108:111]
buffer_load_dwordx4 v[84:87], v2, s[16:19], s37 offen offset:1024
mf a[140:143],a[208:211],v[28:31],a[140:143]
pm v23,v126,v122,s51
mf a[172:175],a[212:215],v[28:31],a[172:175]
mf a[16:19],a[192:195],v[16:19],a[16:19]
pm v24,v103,v99,s50
pm v25,v111,v107,s50
mf a[48:51],a[196:199],v[16:19],a[48:51]
buffer_load_dwordx4 v[88:91], v2, s[16:19], s38 offen
mf a[80:83],a[200:203],v[16:19],a[80:83]
ds_read_b128 a[232:235], v3 offset:13312
mf a[112:115],a[204:207],v[16:19],a[112:115]
pm v26,v119,v115,s50
mf a[144:147],a[208:211],v[16:19],a[144:147]
pm v27,v127,v123,s50
mf a[176:179],a[212:215],v[16:19],a[176:179]
pm v28,v103,v99,s51
mf a[20:23],a[192:195],v[20:23],a[20:23]
pm v29,v111,v107,s51
mf a[52:55],a[196:199],v[20:23],a[52:55]
buffer_load_dwordx4 v[92:95], v2, s[16:19], s38 offen offset:1024
mf a[84:87],a[200:203],v[20:23],a[84:87]
ds_read_b128 a[236:239], v3 offset:14336
mf a[116:119],a[204:207],v[20:23],a[116:119]
pm v30,v119,v115,s51
mf a[148:151],a[208:211],v[20:23],a[148:151]
pm v31,v127,v123,s51
mf a[180:183],a[212:215],v[20:23],a[180:183]
mf a[24:27],a[192:195],v[24:27],a[24:27]
s_waitcnt vmcnt(23)
pm v16,v132,v128,s50
s_add_u32 s100, s89, s92
mf a[56:59],a[196:199],v[24:27],a[56:59]
v_add_u32 v2, s100, v15
mf a[88:91],a[200:203],v[24:27],a[88:91]
buffer_load_dwordx4 v[96:99], v2, s[16:19], 0 offen
mf a[120:123],a[204:207],v[24:27],a[120:123]
s_waitcnt vmcnt(22)
pm v17,v140,v136,s50
mf a[152:155],a[208:211],v[24:27],a[152:155]
s_waitcnt vmcnt(20)
pm v18,v148,v144,s50
mf a[184:187],a[212:215],v[24:27],a[184:187]
s_waitcnt vmcnt(18)
pm v19,v156,v152,s50
buffer_load_dwordx4 v5, s[20:23], s45 offen offset:3072 nt lds
mf a[28:31],a[192:195],v[28:31],a[28:31]
pm v20,v132,v128,s51
mf a[60:63],a[196:199],v[28:31],a[60:63]
pm v21,v140,v136,s51
mf a[92:95],a[200:203],v[28:31],a[92:95]
pm v22,v148,v144,s51
mf a[124:127],a[204:207],v[28:31],a[124:127]
buffer_load_dwordx4 v[100:103], v2, s[16:19], 0 offen offset:1024
mf a[156:159],a[208:211],v[28:31],a[156:159]
pm v23,v156,v152,s51
mf a[188:191],a[212:215],v[28:31],a[188:191]
s_waitcnt lgkmcnt(5)
mf a[0:3],a[216:219],v[16:19],a[0:3]
pm v24,v133,v129,s50
pm v25,v141,v137,s50
s_waitcnt lgkmcnt(4)
mf a[32:35],a[220:223],v[16:19],a[32:35]
buffer_load_dwordx4 v[104:107], v2, s[16:19], s36 offen
s_waitcnt lgkmcnt(3)
mf a[64:67],a[224:227],v[16:19],a[64:67]
s_add_u32 s101, s95, s96
s_waitcnt lgkmcnt(2)
mf a[96:99],a[228:231],v[16:19],a[96:99]
v_add_u32 v3, s101, v12
ds_read_b128 a[192:195], v3 offset:0
s_waitcnt lgkmcnt(2)
mf a[128:131],a[232:235],v[16:19],a[128:131]
pm v26,v149,v145,s50
s_waitcnt lgkmcnt(1)
mf a[160:163],a[236:239],v[16:19],a[160:163]
pm v27,v157,v153,s50
mf a[4:7],a[216:219],v[20:23],a[4:7]
pm v28,v133,v129,s51
mf a[36:39],a[220:223],v[20:23],a[36:39]
pm v29,v141,v137,s51
buffer_load_dwordx4 v[108:111], v2, s[16:19], s36 offen offset:1024
mf a[68:71],a[224:227],v[20:23],a[68:71]
ds_read_b128 a[196:199], v3 offset:1024
mf a[100:103],a[228:231],v[20:23],a[100:103]
pm v30,v149,v145,s51
mf a[132:135],a[232:235],v[20:23],a[132:135]
pm v31,v157,v153,s51
mf a[164:167],a[236:239],v[20:23],a[164:167]
mf a[8:11],a[216:219],v[24:27],a[8:11]
pm v16,v134,v130,s50
buffer_load_dwordx4 v[112:115], v2, s[16:19], s37 offen
mf a[40:43],a[220:223],v[24:27],a[40:43]
pm v17,v142,v138,s50
mf a[72:75],a[224:227],v[24:27],a[72:75]
ds_read_b128 a[200:203], v3 offset:2048
mf a[104:107],a[228:231],v[24:27],a[104:107]
pm v18,v150,v146,s50
pm v19,v158,v154,s50
mf a[136:139],a[232:235],v[24:27],a[136:139]
s_add_u32 m0, s55, 8192
mf a[168:171],a[236:239],v[24:27],a[168:171]
buffer_load_dwordx4 v4, s[20:23], s46 offen nt lds
mf a[12:15],a[216:219],v[28:31],a[12:15]
pm v20,v134,v130,s51
mf a[44:47],a[220:223],v[28:31],a[44:47]
pm v21,v142,v138,s51
ds_read_b128 a[204:207], v3 offset:12288
mf a[76:79],a[224:227],v[28:31],a[76:79]
pm v22,v150,v146,s51
mf a[108:111],a[228:231],v[28:31],a[108:111]
buffer_load_dwordx4 v[116:119], v2, s[16:19], s37 offen offset:1024
mf a[140:143],a[232:235],v[28:31],a[140:143]
pm v23,v158,v154,s51
mf a[172:175],a[236:239],v[28:31],a[172:175]
mf a[16:19],a[216:219],v[16:19],a[16:19]
pm v24,v135,v131,s50
pm v25,v143,v139,s50
mf a[48:51],a[220:223],v[16:19],a[48:51]
buffer_load_dwordx4 v[120:123], v2, s[16:19], s38 offen
mf a[80:83],a[224:227],v[16:19],a[80:83]
ds_read_b128 a[208:211], v3 offset:13312
mf a[112:115],a[228:231],v[16:19],a[112:115]
pm v26,v151,v147,s50
mf a[144:147],a[232:235],v[16:19],a[144:147]
pm v27,v159,v155,s50
mf a[176:179],a[236:239],v[16:19],a[176:179]
pm v28,v135,v131,s51
mf a[20:23],a[216:219],v[20:23],a[20:23]
pm v29,v143,v139,s51
mf a[52:55],a[220:223],v[20:23],a[52:55]
buffer_load_dwordx4 v[124:127], v2, s[16:19], s38 offen offset:1024
mf a[84:87],a[224:227],v[20:23],a[84:87]
ds_read_b128 a[212:215], v3 offset:14336
mf a[116:119],a[228:231],v[20:23],a[116:119]
pm v30,v151,v147,s51
mf a[148:151],a[232:235],v[20:23],a[148:151]
pm v31,v159,v155,s51
mf a[180:183],a[236:239],v[20:23],a[180:183]
mf a[24:27],a[216:219],v[24:27],a[24:27]
s_waitcnt vmcnt(25)
pm v16,v36,v32,s50
s_add_u32 s100, s89, s93
mf a[56:59],a[220:223],v[24:27],a[56:59]
v_add_u32 v2, s100, v15
mf a[88:91],a[224:227],v[24:27],a[88:91]
buffer_load_dwordx4 v[128:131], v2, s[16:19], 0 offen
mf a[120:123],a[228:231],v[24:27],a[120:123]
s_waitcnt vmcnt(24)
pm v17,v44,v40,s50
mf a[152:155],a[232:235],v[24:27],a[152:155]
s_waitcnt vmcnt(22)
pm v18,v52,v48,s50
mf a[184:187],a[236:239],v[24:27],a[184:187]
s_waitcnt vmcnt(20)
pm v19,v60,v56,s50
buffer_load_dwordx4 v4, s[20:23], s46 offen offset:1024 nt lds
mf a[28:31],a[216:219],v[28:31],a[28:31]
pm v20,v36,v32,s51
mf a[60:63],a[220:223],v[28:31],a[60:63]
pm v21,v44,v40,s51
mf a[92:95],a[224:227],v[28:31],a[92:95]
pm v22,v52,v48,s51
mf a[124:127],a[228:231],v[28:31],a[124:127]
buffer_load_dwordx4 v[132:135], v2, s[16:19], 0 offen offset:1024
mf a[156:159],a[232:235],v[28:31],a[156:159]
pm v23,v60,v56,s51
mf a[188:191],a[236:239],v[28:31],a[188:191]
s_waitcnt lgkmcnt(5)
mf a[0:3],a[192:195],v[16:19],a[0:3]
pm v24,v37,v33,s50
pm v25,v45,v41,s50
s_waitcnt lgkmcnt(4)
mf a[32:35],a[196:199],v[16:19],a[32:35]
buffer_load_dwordx4 v[136:139], v2, s[16:19], s36 offen
s_waitcnt lgkmcnt(3)
mf a[64:67],a[200:203],v[16:19],a[64:67]
s_add_u32 s101, s95, s97
s_waitcnt lgkmcnt(2)
mf a[96:99],a[204:207],v[16:19],a[96:99]
v_add_u32 v3, s101, v12
ds_read_b128 a[216:219], v3 offset:0
s_waitcnt lgkmcnt(2)
mf a[128:131],a[208:211],v[16:19],a[128:131]
pm v26,v53,v49,s50
s_waitcnt lgkmcnt(1)
mf a[160:163],a[212:215],v[16:19],a[160:163]
pm v27,v61,v57,s50
mf a[4:7],a[192:195],v[20:23],a[4:7]
pm v28,v37,v33,s51
mf a[36:39],a[196:199],v[20:23],a[36:39]
pm v29,v45,v41,s51
buffer_load_dwordx4 v[140:143], v2, s[16:19], s36 offen offset:1024
mf a[68:71],a[200:203],v[20:23],a[68:71]
ds_read_b128 a[220:223], v3 offset:1024
mf a[100:103],a[204:207],v[20:23],a[100:103]
pm v30,v53,v49,s51
mf a[132:135],a[208:211],v[20:23],a[132:135]
pm v31,v61,v57,s51
mf a[164:167],a[212:215],v[20:23],a[164:167]
mf a[8:11],a[192:195],v[24:27],a[8:11]
pm v16,v38,v34,s50
buffer_load_dwordx4 v[144:147], v2, s[16:19], s37 offen
mf a[40:43],a[196:199],v[24:27],a[40:43]
pm v17,v46,v42,s50
mf a[72:75],a[200:203],v[24:27],a[72:75]
ds_read_b128 a[224:227], v3 offset:2048
mf a[104:107],a[204:207],v[24:27],a[104:107]
pm v18,v54,v50,s50
mf a[136:139],a[208:211],v[24:27],a[136:139]
pm v19,v62,v58,s50
mf a[168:171],a[212:215],v[24:27],a[168:171]
buffer_load_dwordx4 v5, s[20:23], s46 offen offset:2048 nt lds
pm v20,v38,v34,s51
mf a[12:15],a[192:195],v[28:31],a[12:15]
pm v21,v46,v42,s51
mf a[44:47],a[196:199],v[28:31],a[44:47]
ds_read_b128 a[228:231], v3 offset:12288
mf a[76:79],a[200:203],v[28:31],a[76:79]
pm v22,v54,v50,s51
mf a[108:111],a[204:207],v[28:31],a[108:111]
buffer_load_dwordx4 v[148:151], v2, s[16:19], s37 offen offset:1024
mf a[140:143],a[208:211],v[28:31],a[140:143]
pm v23,v62,v58,s51
mf a[172:175],a[212:215],v[28:31],a[172:175]
mf a[16:19],a[192:195],v[16:19],a[16:19]
pm v24,v39,v35,s50
pm v25,v47,v43,s50
mf a[48:51],a[196:199],v[16:19],a[48:51]
buffer_load_dwordx4 v[152:155], v2, s[16:19], s38 offen
mf a[80:83],a[200:203],v[16:19],a[80:83]
ds_read_b128 a[232:235], v3 offset:13312
mf a[112:115],a[204:207],v[16:19],a[112:115]
pm v26,v55,v51,s50
mf a[144:147],a[208:211],v[16:19],a[144:147]
pm v27,v63,v59,s50
mf a[176:179],a[212:215],v[16:19],a[176:179]
pm v28,v39,v35,s51
mf a[20:23],a[192:195],v[20:23],a[20:23]
pm v29,v47,v43,s51
mf a[52:55],a[196:199],v[20:23],a[52:55]
buffer_load_dwordx4 v[156:159], v2, s[16:19], s38 offen offset:1024
mf a[84:87],a[200:203],v[20:23],a[84:87]
ds_read_b128 a[236:239], v3 offset:14336
mf a[116:119],a[204:207],v[20:23],a[116:119]
pm v30,v55,v51,s51
mf a[148:151],a[208:211],v[20:23],a[148:151]
pm v31,v63,v59,s51
mf a[180:183],a[212:215],v[20:23],a[180:183]
mf a[24:27],a[192:195],v[24:27],a[24:27]
s_waitcnt vmcnt(27)
pm v16,v68,v64,s50
v_add_u32 v15, 0x40000, v15
mf a[56:59],a[196:199],v[24:27],a[56:59]
s_add_u32 s100, s88, s90
mf a[88:91],a[200:203],v[24:27],a[88:91]
v_add_u32 v2, s100, v15
mf a[120:123],a[204:207],v[24:27],a[120:123]
buffer_load_dwordx4 v[32:35], v2, s[16:19], 0 offen
s_waitcnt vmcnt(26)
pm v17,v76,v72,s50
mf a[152:155],a[208:211],v[24:27],a[152:155]
s_waitcnt vmcnt(23)
pm v18,v84,v80,s50
mf a[184:187],a[212:215],v[24:27],a[184:187]
s_waitcnt vmcnt(21)
pm v19,v92,v88,s50
mf a[28:31],a[192:195],v[28:31],a[28:31]
buffer_load_dwordx4 v5, s[20:23], s46 offen offset:3072 nt lds
mf a[60:63],a[196:199],v[28:31],a[60:63]
pm v20,v68,v64,s51
pm v21,v76,v72,s51
mf a[92:95],a[200:203],v[28:31],a[92:95]
pm v22,v84,v80,s51
mf a[124:127],a[204:207],v[28:31],a[124:127]
buffer_load_dwordx4 v[36:39], v2, s[16:19], 0 offen offset:1024
mf a[156:159],a[208:211],v[28:31],a[156:159]
pm v23,v92,v88,s51
mf a[188:191],a[212:215],v[28:31],a[188:191]
s_waitcnt lgkmcnt(5)
mf a[0:3],a[216:219],v[16:19],a[0:3]
pm v24,v69,v65,s50
pm v25,v77,v73,s50
s_waitcnt lgkmcnt(4)
mf a[32:35],a[220:223],v[16:19],a[32:35]
buffer_load_dwordx4 v[40:43], v2, s[16:19], s36 offen
s_waitcnt lgkmcnt(3)
mf a[64:67],a[224:227],v[16:19],a[64:67]
s_add_u32 s101, s95, s98
s_waitcnt lgkmcnt(2)
mf a[96:99],a[228:231],v[16:19],a[96:99]
v_add_u32 v3, s101, v12
ds_read_b128 a[192:195], v3 offset:0
s_waitcnt lgkmcnt(2)
mf a[128:131],a[232:235],v[16:19],a[128:131]
pm v26,v85,v81,s50
s_waitcnt lgkmcnt(1)
mf a[160:163],a[236:239],v[16:19],a[160:163]
pm v27,v93,v89,s50
mf a[4:7],a[216:219],v[20:23],a[4:7]
pm v28,v69,v65,s51
mf a[36:39],a[220:223],v[20:23],a[36:39]
pm v29,v77,v73,s51
buffer_load_dwordx4 v[44:47], v2, s[16:19], s36 offen offset:1024
mf a[68:71],a[224:227],v[20:23],a[68:71]
ds_read_b128 a[196:199], v3 offset:1024
mf a[100:103],a[228:231],v[20:23],a[100:103]
pm v30,v85,v81,s51
mf a[132:135],a[232:235],v[20:23],a[132:135]
pm v31,v93,v89,s51
mf a[164:167],a[236:239],v[20:23],a[164:167]
mf a[8:11],a[216:219],v[24:27],a[8:11]
pm v16,v70,v66,s50
buffer_load_dwordx4 v[48:51], v2, s[16:19], s37 offen
mf a[40:43],a[220:223],v[24:27],a[40:43]
pm v17,v78,v74,s50
mf a[72:75],a[224:227],v[24:27],a[72:75]
ds_read_b128 a[200:203], v3 offset:2048
mf a[104:107],a[228:231],v[24:27],a[104:107]
pm v18,v86,v82,s50
mf a[136:139],a[232:235],v[24:27],a[136:139]
pm v19,v94,v90,s50
mf a[168:171],a[236:239],v[24:27],a[168:171]
buffer_load_dwordx4 v[160:163], v6, s[24:27], s44 offen nt
pm v20,v70,v66,s51
mf a[12:15],a[216:219],v[28:31],a[12:15]
pm v21,v78,v74,s51
mf a[44:47],a[220:223],v[28:31],a[44:47]
ds_read_b128 a[204:207], v3 offset:12288
mf a[76:79],a[224:227],v[28:31],a[76:79]
pm v22,v86,v82,s51
mf a[108:111],a[228:231],v[28:31],a[108:111]
buffer_load_dwordx4 v[52:55], v2, s[16:19], s37 offen offset:1024
mf a[140:143],a[232:235],v[28:31],a[140:143]
pm v23,v94,v90,s51
mf a[172:175],a[236:239],v[28:31],a[172:175]
mf a[16:19],a[216:219],v[16:19],a[16:19]
pm v24,v71,v67,s50
pm v25,v79,v75,s50
mf a[48:51],a[220:223],v[16:19],a[48:51]
buffer_load_dwordx4 v[56:59], v2, s[16:19], s38 offen
mf a[80:83],a[224:227],v[16:19],a[80:83]
ds_read_b128 a[208:211], v3 offset:13312
mf a[112:115],a[228:231],v[16:19],a[112:115]
pm v26,v87,v83,s50
mf a[144:147],a[232:235],v[16:19],a[144:147]
pm v27,v95,v91,s50
mf a[176:179],a[236:239],v[16:19],a[176:179]
pm v28,v71,v67,s51
mf a[20:23],a[216:219],v[20:23],a[20:23]
pm v29,v79,v75,s51
mf a[52:55],a[220:223],v[20:23],a[52:55]
buffer_load_dwordx4 v[60:63], v2, s[16:19], s38 offen offset:1024
mf a[84:87],a[224:227],v[20:23],a[84:87]
ds_read_b128 a[212:215], v3 offset:14336
mf a[116:119],a[228:231],v[20:23],a[116:119]
pm v30,v87,v83,s51
mf a[148:151],a[232:235],v[20:23],a[148:151]
pm v31,v95,v91,s51
mf a[180:183],a[236:239],v[20:23],a[180:183]
mf a[24:27],a[216:219],v[24:27],a[24:27]
s_waitcnt vmcnt(27)
pm v16,v100,v96,s50
mf a[56:59],a[220:223],v[24:27],a[56:59]
s_waitcnt vmcnt(25)
pm v17,v108,v104,s50
mf a[88:91],a[224:227],v[24:27],a[88:91]
s_waitcnt vmcnt(22)
pm v18,v116,v112,s50
mf a[120:123],a[228:231],v[24:27],a[120:123]
s_waitcnt vmcnt(20)
pm v19,v124,v120,s50
mf a[152:155],a[232:235],v[24:27],a[152:155]
buffer_load_dwordx4 v[164:167], v6, s[24:27], s44 offen offset:256 nt
mf a[184:187],a[236:239],v[24:27],a[184:187]
mf a[28:31],a[216:219],v[28:31],a[28:31]
pm v20,v100,v96,s51
mf a[60:63],a[220:223],v[28:31],a[60:63]
pm v21,v108,v104,s51
mf a[92:95],a[224:227],v[28:31],a[92:95]
pm v22,v116,v112,s51
mf a[124:127],a[228:231],v[28:31],a[124:127]
pm v23,v124,v120,s51
mf a[156:159],a[232:235],v[28:31],a[156:159]
mf a[188:191],a[236:239],v[28:31],a[188:191]
s_waitcnt lgkmcnt(5)
mf a[0:3],a[192:195],v[16:19],a[0:3]
pm v24,v101,v97,s50
pm v25,v109,v105,s50
s_waitcnt lgkmcnt(4)
mf a[32:35],a[196:199],v[16:19],a[32:35]
s_add_u32 s101, s95, s99
s_waitcnt lgkmcnt(3)
mf a[64:67],a[200:203],v[16:19],a[64:67]
v_add_u32 v3, s101, v12
s_waitcnt lgkmcnt(2)
mf a[96:99],a[204:207],v[16:19],a[96:99]
ds_read_b128 a[216:219], v3 offset:0
s_waitcnt lgkmcnt(2)
mf a[128:131],a[208:211],v[16:19],a[128:131]
pm v26,v117,v113,s50
s_waitcnt lgkmcnt(1)
mf a[160:163],a[212:215],v[16:19],a[160:163]
pm v27,v125,v121,s50
mf a[4:7],a[192:195],v[20:23],a[4:7]
pm v28,v101,v97,s51
mf a[36:39],a[196:199],v[20:23],a[36:39]
pm v29,v109,v105,s51
mf a[68:71],a[200:203],v[20:23],a[68:71]
ds_read_b128 a[220:223], v3 offset:1024
mf a[100:103],a[204:207],v[20:23],a[100:103]
pm v30,v117,v113,s51
mf a[132:135],a[208:211],v[20:23],a[132:135]
pm v31,v125,v121,s51
mf a[164:167],a[212:215],v[20:23],a[164:167]
mf a[8:11],a[192:195],v[24:27],a[8:11]
pm v16,v102,v98,s50
mf a[40:43],a[196:199],v[24:27],a[40:43]
pm v17,v110,v106,s50
mf a[72:75],a[200:203],v[24:27],a[72:75]
ds_read_b128 a[224:227], v3 offset:2048
mf a[104:107],a[204:207],v[24:27],a[104:107]
pm v18,v118,v114,s50
mf a[136:139],a[208:211],v[24:27],a[136:139]
pm v19,v126,v122,s50
mf a[168:171],a[212:215],v[24:27],a[168:171]
buffer_load_dwordx4 v[168:171], v6, s[24:27], s44 offen offset:512 nt
mf a[12:15],a[192:195],v[28:31],a[12:15]
pm v20,v102,v98,s51
mf a[44:47],a[196:199],v[28:31],a[44:47]
pm v21,v110,v106,s51
mf a[76:79],a[200:203],v[28:31],a[76:79]
ds_read_b128 a[228:231], v3 offset:12288
mf a[108:111],a[204:207],v[28:31],a[108:111]
pm v22,v118,v114,s51
mf a[140:143],a[208:211],v[28:31],a[140:143]
pm v23,v126,v122,s51
mf a[172:175],a[212:215],v[28:31],a[172:175]
mf a[16:19],a[192:195],v[16:19],a[16:19]
pm v24,v103,v99,s50
mf a[48:51],a[196:199],v[16:19],a[48:51]
pm v25,v111,v107,s50
mf a[80:83],a[200:203],v[16:19],a[80:83]
ds_read_b128 a[232:235], v3 offset:13312
mf a[112:115],a[204:207],v[16:19],a[112:115]
pm v26,v119,v115,s50
mf a[144:147],a[208:211],v[16:19],a[144:147]
pm v27,v127,v123,s50
mf a[176:179],a[212:215],v[16:19],a[176:179]
buffer_load_dwordx4 v[172:175], v6, s[24:27], s44 offen offset:768 nt
mf a[20:23],a[192:195],v[20:23],a[20:23]
pm v28,v103,v99,s51
mf a[52:55],a[196:199],v[20:23],a[52:55]
pm v29,v111,v107,s51
mf a[84:87],a[200:203],v[20:23],a[84:87]
ds_read_b128 a[236:239], v3 offset:14336
mf a[116:119],a[204:207],v[20:23],a[116:119]
pm v30,v119,v115,s51
mf a[148:151],a[208:211],v[20:23],a[148:151]
pm v31,v127,v123,s51
mf a[180:183],a[212:215],v[20:23],a[180:183]
mf a[24:27],a[192:195],v[24:27],a[24:27]
s_waitcnt vmcnt(20)
pm v16,v132,v128,s50
mf a[56:59],a[196:199],v[24:27],a[56:59]
s_waitcnt vmcnt(18)
pm v17,v140,v136,s50
mf a[88:91],a[200:203],v[24:27],a[88:91]
s_waitcnt vmcnt(15)
pm v18,v148,v144,s50
mf a[120:123],a[204:207],v[24:27],a[120:123]
s_waitcnt vmcnt(13)
pm v19,v156,v152,s50
mf a[152:155],a[208:211],v[24:27],a[152:155]
buffer_load_dwordx4 v[176:179], v6, s[24:27], s45 offen nt
mf a[184:187],a[212:215],v[24:27],a[184:187]
mf a[28:31],a[192:195],v[28:31],a[28:31]
pm v20,v132,v128,s51
mf a[60:63],a[196:199],v[28:31],a[60:63]
pm v21,v140,v136,s51
mf a[92:95],a[200:203],v[28:31],a[92:95]
pm v22,v148,v144,s51
mf a[124:127],a[204:207],v[28:31],a[124:127]
pm v23,v156,v152,s51
mf a[156:159],a[208:211],v[28:31],a[156:159]
mf a[188:191],a[212:215],v[28:31],a[188:191]
s_waitcnt lgkmcnt(5)
mf a[0:3],a[216:219],v[16:19],a[0:3]
pm v24,v133,v129,s50
s_waitcnt lgkmcnt(4)
mf a[32:35],a[220:223],v[16:19],a[32:35]
pm v25,v141,v137,s50
s_waitcnt lgkmcnt(3)
mf a[64:67],a[224:227],v[16:19],a[64:67]
pm v26,v149,v145,s50
s_waitcnt lgkmcnt(2)
mf a[96:99],a[228:231],v[16:19],a[96:99]
s_waitcnt lgkmcnt(1)
mf a[128:131],a[232:235],v[16:19],a[128:131]
pm v27,v157,v153,s50
s_waitcnt lgkmcnt(0)
mf a[160:163],a[236:239],v[16:19],a[160:163]
pm v28,v133,v129,s51
mf a[4:7],a[216:219],v[20:23],a[4:7]
pm v29,v141,v137,s51
mf a[36:39],a[220:223],v[20:23],a[36:39]
mf a[68:71],a[224:227],v[20:23],a[68:71]
pm v30,v149,v145,s51
mf a[100:103],a[228:231],v[20:23],a[100:103]
pm v31,v157,v153,s51
mf a[132:135],a[232:235],v[20:23],a[132:135]
mf a[164:167],a[236:239],v[20:23],a[164:167]
mf a[8:11],a[216:219],v[24:27],a[8:11]
pm v16,v134,v130,s50
mf a[40:43],a[220:223],v[24:27],a[40:43]
pm v17,v142,v138,s50
mf a[72:75],a[224:227],v[24:27],a[72:75]
pm v18,v150,v146,s50
mf a[104:107],a[228:231],v[24:27],a[104:107]
pm v19,v158,v154,s50
mf a[136:139],a[232:235],v[24:27],a[136:139]
buffer_load_dwordx4 v[180:183], v6, s[24:27], s45 offen offset:256 nt
mf a[168:171],a[236:239],v[24:27],a[168:171]
mf a[12:15],a[216:219],v[28:31],a[12:15]
pm v20,v134,v130,s51
mf a[44:47],a[220:223],v[28:31],a[44:47]
pm v21,v142,v138,s51
mf a[76:79],a[224:227],v[28:31],a[76:79]
pm v22,v150,v146,s51
mf a[108:111],a[228:231],v[28:31],a[108:111]
pm v23,v158,v154,s51
mf a[140:143],a[232:235],v[28:31],a[140:143]
mf a[172:175],a[236:239],v[28:31],a[172:175]
mf a[16:19],a[216:219],v[16:19],a[16:19]
pm v24,v135,v131,s50
mf a[48:51],a[220:223],v[16:19],a[48:51]
pm v25,v143,v139,s50
mf a[80:83],a[224:227],v[16:19],a[80:83]
pm v26,v151,v147,s50
mf a[112:115],a[228:231],v[16:19],a[112:115]
pm v27,v159,v155,s50
mf a[144:147],a[232:235],v[16:19],a[144:147]
buffer_load_dwordx4 v[184:187], v6, s[24:27], s45 offen offset:512 nt
mf a[176:179],a[236:239],v[16:19],a[176:179]
mf a[20:23],a[216:219],v[20:23],a[20:23]
pm v28,v135,v131,s51
mf a[52:55],a[220:223],v[20:23],a[52:55]
pm v29,v143,v139,s51
mf a[84:87],a[224:227],v[20:23],a[84:87]
pm v30,v151,v147,s51
mf a[116:119],a[228:231],v[20:23],a[116:119]
pm v31,v159,v155,s51
mf a[148:151],a[232:235],v[20:23],a[148:151]
mf a[180:183],a[236:239],v[20:23],a[180:183]
mf a[24:27],a[216:219],v[24:27],a[24:27]
buffer_load_dwordx4 v[188:191], v6, s[24:27], s45 offen offset:768 nt
mf a[56:59],a[220:223],v[24:27],a[56:59]
mf a[88:91],a[224:227],v[24:27],a[88:91]
mf a[120:123],a[228:231],v[24:27],a[120:123]
mf a[152:155],a[232:235],v[24:27],a[152:155]
mf a[184:187],a[236:239],v[24:27],a[184:187]
mf a[28:31],a[216:219],v[28:31],a[28:31]
mf a[60:63],a[220:223],v[28:31],a[60:63]
mf a[92:95],a[224:227],v[28:31],a[92:95]
mf a[124:127],a[228:231],v[28:31],a[124:127]
mf a[156:159],a[232:235],v[28:31],a[156:159]
mf a[188:191],a[236:239],v[28:31],a[188:191]
ds_read_b128 v[64:67], v14 offset:49152
buffer_load_dwordx4 v[192:195], v6, s[24:27], s46 offen nt
s_add_u32 s100, s88, s91
v_add_u32 v2, s100, v15
s_waitcnt vmcnt(16)
ds_read_b128 a[192:195], v8 offset:0
s_add_u32 s100, s88, s92
ds_read_b128 a[208:211], v8 offset:4096
ds_read_b128 a[224:227], v8 offset:8192
ds_read_b128 v[68:71], v14 offset:52224
buffer_load_dwordx4 v[196:199], v6, s[24:27], s46 offen offset:256 nt
ds_read_b128 a[196:199], v9 offset:0
ds_read_b128 a[212:215], v9 offset:4096
ds_read_b128 a[228:231], v9 offset:8192
ds_read_b128 v[72:75], v14 offset:55296
buffer_load_dwordx4 v[200:203], v6, s[24:27], s46 offen offset:512 nt
s_waitcnt lgkmcnt(7)
mf v[96:99],a[192:195],v[64:67],0
ds_read_b128 a[200:203], v10 offset:0
s_waitcnt lgkmcnt(7)
mf v[100:103],a[208:211],v[64:67],0
ds_read_b128 a[216:219], v10 offset:4096
s_waitcnt lgkmcnt(7)
mf v[104:107],a[224:227],v[64:67],0
ds_read_b128 a[232:235], v10 offset:8192
ds_read_b128 v[76:79], v14 offset:58368
s_waitcnt lgkmcnt(7)
mf v[96:99],a[196:199],v[68:71],v[96:99]
ds_read_b128 a[204:207], v11 offset:0
buffer_load_dwordx4 v[204:207], v6, s[24:27], s46 offen offset:768 nt
s_waitcnt lgkmcnt(7)
mf v[100:103],a[212:215],v[68:71],v[100:103]
ds_read_b128 a[220:223], v11 offset:4096
s_waitcnt lgkmcnt(7)
mf v[104:107],a[228:231],v[68:71],v[104:107]
ds_read_b128 a[236:239], v11 offset:8192
ds_read_b128 v[80:83], v14 offset:50176
ds_read_b128 v[84:87], v14 offset:53248
s_waitcnt lgkmcnt(8)
mf v[96:99],a[200:203],v[72:75],v[96:99]
buffer_load_dwordx4 v[64:67], v2, s[16:19], 0 offen
ds_read_b128 v[88:91], v14 offset:56320
s_waitcnt lgkmcnt(8)
mf v[100:103],a[216:219],v[72:75],v[100:103]
ds_read_b128 v[92:95], v14 offset:59392
s_waitcnt lgkmcnt(8)
mf v[104:107],a[232:235],v[72:75],v[104:107]
ds_read_b128 a[240:243], v14 offset:51200
ds_read_b128 a[244:247], v14 offset:54272
s_waitcnt lgkmcnt(8)
mf v[96:99],a[204:207],v[76:79],v[96:99]
ds_read_b128 a[248:251], v14 offset:57344
s_waitcnt lgkmcnt(8)
mf v[100:103],a[220:223],v[76:79],v[100:103]
buffer_load_dwordx4 v[68:71], v2, s[16:19], 0 offen offset:1024
ds_read_b128 a[252:255], v14 offset:60416
s_waitcnt lgkmcnt(8)
mf v[104:107],a[236:239],v[76:79],v[104:107]
s_nop 0
v_max3_f32 v146, v96, v97, v98
s_waitcnt lgkmcnt(7)
mf v[108:111],a[192:195],v[80:83],0
v_max3_f32 v147, v99, v100, v101
v_max3_f32 v146, v146, v102, v103
mf v[112:115],a[208:211],v[80:83],0
s_nop 0
v_max3_f32 v147, v147, v104, v105
v_max3_f32 v146, v146, v106, v107
mf v[116:119],a[224:227],v[80:83],0
v_max_f32 v146, v146, v147
buffer_load_dwordx4 v[72:75], v2, s[16:19], s36 offen
s_waitcnt lgkmcnt(6)
mf v[108:111],a[196:199],v[84:87],v[108:111]
v_mov_b32 v147, v146
s_waitcnt lgkmcnt(3)
mf v[120:123],a[192:195],a[240:243],0
v_permlane16_swap_b32 v146, v147
mf v[124:127],a[208:211],a[240:243],0
v_max_f32 v146, v146, v147
v_mov_b32 v147, v146
mf v[152:155],a[224:227],a[240:243],0
s_nop 0
v_permlane32_swap_b32 v146, v147
s_waitcnt lgkmcnt(2)
mf v[120:123],a[196:199],a[244:247],v[120:123]
buffer_load_dwordx4 v[76:79], v2, s[16:19], s36 offen offset:1024
v_max_f32 v146, v146, v147
mf v[112:115],a[212:215],v[84:87],v[112:115]
v_mul_f32 v146, s52, v146
v_fma_f32 v96, v96, s52, -v146
mf v[124:127],a[212:215],a[244:247],v[124:127]
v_fma_f32 v97, v97, s52, -v146
v_fma_f32 v98, v98, s52, -v146
mf v[116:119],a[228:231],v[84:87],v[116:119]
v_fma_f32 v99, v99, s52, -v146
v_exp_f32 v96, v96
mf v[152:155],a[228:231],a[244:247],v[152:155]
buffer_load_dwordx4 v[80:83], v2, s[16:19], s37 offen
v_exp_f32 v97, v97
mf v[108:111],a[200:203],v[88:91],v[108:111]
v_exp_f32 v98, v98
s_waitcnt lgkmcnt(1)
mf v[120:123],a[200:203],a[248:251],v[120:123]
v_exp_f32 v99, v99
mf v[112:115],a[216:219],v[88:91],v[112:115]
v_fma_f32 v100, v100, s52, -v146
v_fma_f32 v101, v101, s52, -v146
mf v[124:127],a[216:219],a[248:251],v[124:127]
buffer_load_dwordx4 v[84:87], v2, s[16:19], s37 offen offset:1024
v_exp_f32 v100, v100
mf v[116:119],a[232:235],v[88:91],v[116:119]
v_exp_f32 v101, v101
mf v[152:155],a[232:235],a[248:251],v[152:155]
v_fma_f32 v102, v102, s52, -v146
v_fma_f32 v103, v103, s52, -v146
mf v[108:111],a[204:207],v[92:95],v[108:111]
v_fma_f32 v104, v104, s52, -v146
v_fma_f32 v105, v105, s52, -v146
s_waitcnt lgkmcnt(0)
mf v[120:123],a[204:207],a[252:255],v[120:123]
buffer_load_dwordx4 v[88:91], v2, s[16:19], s38 offen
v_fma_f32 v106, v106, s52, -v146
mf v[112:115],a[220:223],v[92:95],v[112:115]
s_nop 0
v_max3_f32 v148, v108, v109, v110
v_fma_f32 v107, v107, s52, -v146
mf v[124:127],a[220:223],a[252:255],v[124:127]
s_nop 0
v_max3_f32 v150, v120, v121, v122
v_exp_f32 v102, v102
mf v[116:119],a[236:239],v[92:95],v[116:119]
v_max3_f32 v149, v111, v112, v113
v_max3_f32 v148, v148, v114, v115
mf v[152:155],a[236:239],a[252:255],v[152:155]
buffer_load_dwordx4 v[92:95], v2, s[16:19], s38 offen offset:1024
v_max3_f32 v151, v123, v124, v125
v_max3_f32 v150, v150, v126, v127
v_exp_f32 v103, v103
s_nop 0
v_max3_f32 v149, v149, v116, v117
v_max3_f32 v148, v148, v118, v119
v_max_f32 v148, v148, v149
v_max3_f32 v151, v151, v152, v153
v_max3_f32 v150, v150, v154, v155
v_max_f32 v150, v150, v151
v_mov_b32 v149, v148
v_mov_b32 v151, v150
v_add_f32 v146, v96, v97
v_permlane16_swap_b32 v148, v149
v_permlane16_swap_b32 v150, v151
v_max_f32 v148, v148, v149
v_max_f32 v150, v150, v151
v_mov_b32 v149, v148
v_mov_b32 v151, v150
v_add_f32 v147, v98, v99
v_permlane32_swap_b32 v148, v149
v_permlane32_swap_b32 v150, v151
v_max_f32 v148, v148, v149
v_max_f32 v150, v150, v151
v_mul_f32 v148, s52, v148
v_mul_f32 v150, s52, v150
v_fma_f32 v108, v108, s52, -v148
v_fma_f32 v109, v109, s52, -v148
v_fma_f32 v110, v110, s52, -v148
v_fma_f32 v111, v111, s52, -v148
v_fma_f32 v120, v120, s52, -v150
v_fma_f32 v121, v121, s52, -v150
v_fma_f32 v122, v122, s52, -v150
v_fma_f32 v123, v123, s52, -v150
v_exp_f32 v108, v108
v_exp_f32 v109, v109
v_exp_f32 v110, v110
v_exp_f32 v111, v111
v_fma_f32 v112, v112, s52, -v148
v_fma_f32 v113, v113, s52, -v148
v_exp_f32 v120, v120
v_exp_f32 v121, v121
v_exp_f32 v122, v122
v_exp_f32 v123, v123
v_fma_f32 v124, v124, s52, -v150
v_fma_f32 v125, v125, s52, -v150
v_exp_f32 v112, v112
v_exp_f32 v113, v113
v_fma_f32 v114, v114, s52, -v148
v_fma_f32 v115, v115, s52, -v148
v_exp_f32 v124, v124
v_exp_f32 v125, v125
v_fma_f32 v126, v126, s52, -v150
v_fma_f32 v127, v127, s52, -v150
v_fma_f32 v116, v116, s52, -v148
v_fma_f32 v117, v117, s52, -v148
v_fma_f32 v118, v118, s52, -v148
v_fma_f32 v119, v119, s52, -v148
v_exp_f32 v114, v114
v_exp_f32 v115, v115
v_exp_f32 v104, v104
v_exp_f32 v105, v105
v_add_f32 v148, v108, v109
v_add_f32 v149, v110, v111
v_fma_f32 v152, v152, s52, -v150
v_fma_f32 v153, v153, s52, -v150
v_fma_f32 v154, v154, s52, -v150
v_fma_f32 v155, v155, s52, -v150
v_exp_f32 v126, v126
v_exp_f32 v127, v127
v_add_f32 v147, v147, v100
v_add_f32 v146, v146, v101
v_exp_f32 v116, v116
v_exp_f32 v117, v117
v_add_f32 v150, v120, v121
v_add_f32 v151, v122, v123
v_exp_f32 v106, v106
v_exp_f32 v107, v107
v_add_f32 v149, v149, v112
v_add_f32 v148, v148, v113
v_exp_f32 v152, v152
v_exp_f32 v153, v153
v_add_f32 v147, v147, v102
v_add_f32 v146, v146, v103
v_exp_f32 v118, v118
v_exp_f32 v119, v119
v_add_f32 v151, v151, v124
v_add_f32 v150, v150, v125
v_add_f32 v149, v149, v114
v_add_f32 v148, v148, v115
v_exp_f32 v154, v154
v_exp_f32 v155, v155
v_add_f32 v147, v147, v104
v_add_f32 v146, v146, v105
v_add_f32 v151, v151, v126
v_add_f32 v150, v150, v127
v_add_f32 v149, v149, v116
v_add_f32 v148, v148, v117
v_add_f32 v147, v147, v106
v_add_f32 v146, v146, v107
v_add_f32 v151, v151, v152
v_add_f32 v150, v150, v153
v_add_f32 v149, v149, v118
v_add_f32 v148, v148, v119
v_add_f32 v146, v146, v147
v_add_f32 v151, v151, v154
v_add_f32 v150, v150, v155
v_add_f32 v148, v148, v149
v_mov_b32 v147, v146
v_add_f32 v150, v150, v151
v_mov_b32 v149, v148
v_mov_b32 v151, v150
v_permlane16_swap_b32 v146, v147
v_permlane16_swap_b32 v148, v149
v_permlane16_swap_b32 v150, v151
v_add_f32 v146, v146, v147
v_add_f32 v148, v148, v149
v_mov_b32 v147, v146
v_add_f32 v150, v150, v151
v_mov_b32 v149, v148
v_mov_b32 v151, v150
v_permlane32_swap_b32 v146, v147
v_permlane32_swap_b32 v148, v149
v_permlane32_swap_b32 v150, v151
v_add_f32 v146, v146, v147
v_add_f32 v148, v148, v149
v_rcp_f32 v146, v146
v_add_f32 v150, v150, v151
v_rcp_f32 v148, v148
v_rcp_f32 v150, v150
v_mul_f32 v96, v96, v146
v_mul_f32 v97, v97, v146
v_mul_f32 v98, v98, v146
v_mul_f32 v99, v99, v146
v_mul_f32 v100, v100, v146
v_mul_f32 v101, v101, v146
v_mul_f32 v102, v102, v146
v_mul_f32 v103, v103, v146
v_mul_f32 v108, v108, v148
v_mul_f32 v109, v109, v148
v_mul_f32 v110, v110, v148
v_mul_f32 v111, v111, v148
v_mul_f32 v112, v112, v148
v_mul_f32 v113, v113, v148
v_mul_f32 v114, v114, v148
v_mul_f32 v115, v115, v148
cv v128,v96,v97
cv v129,v98,v99
cv v130,v100,v101
cv v131,v102,v103
s_waitcnt vmcnt(18)
pm v208,v164,v160,s50
s_waitcnt vmcnt(16)
pm v209,v172,v168,s50
s_waitcnt vmcnt(14)
pm v210,v180,v176,s50
s_waitcnt vmcnt(12)
pm v211,v188,v184,s50
pm v212,v164,v160,s51
pm v213,v172,v168,s51
mf v[232:235],v[208:211],v[128:131],0
pm v214,v180,v176,s51
pm v215,v188,v184,s51
v_mul_f32 v120, v120, v150
v_mul_f32 v121, v121, v150
mf v[236:239],v[212:215],v[128:131],0
v_mul_f32 v122, v122, v150
v_mul_f32 v123, v123, v150
v_mul_f32 v124, v124, v150
v_mul_f32 v125, v125, v150
v_mul_f32 v126, v126, v150
v_mul_f32 v127, v127, v150
cv v132,v108,v109
cv v133,v110,v111
cv v134,v112,v113
cv v135,v114,v115
cv v136,v120,v121
cv v137,v122,v123
mf v[240:243],v[208:211],v[132:135],0
cv v138,v124,v125
cv v139,v126,v127
mf v[244:247],v[212:215],v[132:135],0
v_mul_f32 v104, v104, v146
v_mul_f32 v105, v105, v146
mf v[248:251],v[208:211],v[136:139],0
v_mul_f32 v106, v106, v146
v_mul_f32 v107, v107, v146
mf v[252:255],v[212:215],v[136:139],0
v_mul_f32 v116, v116, v148
v_mul_f32 v117, v117, v148
v_mul_f32 v118, v118, v148
v_mul_f32 v119, v119, v148
cv v140,v104,v105
cv v141,v106,v107
s_waitcnt vmcnt(10)
pm v216,v196,v192,s50
s_waitcnt vmcnt(8)
pm v217,v204,v200,s50
pm v218,v196,v192,s51
pm v219,v204,v200,s51
v_mfma_f32_16x16x16_bf16 v[232:235], v[216:217], v[140:141], v[232:235]
v_mul_f32 v152, v152, v150
v_mul_f32 v153, v153, v150
v_mfma_f32_16x16x16_bf16 v[236:239], v[218:219], v[140:141], v[236:239]
v_mul_f32 v154, v154, v150
v_mul_f32 v155, v155, v150
cv v142,v116,v117
cv v143,v118,v119
cv v144,v152,v153
cv v145,v154,v155
v_mfma_f32_16x16x16_bf16 v[240:243], v[216:217], v[142:143], v[240:243]
pm v220,v165,v161,s50
pm v221,v173,v169,s50
v_mfma_f32_16x16x16_bf16 v[244:247], v[218:219], v[142:143], v[244:247]
pm v222,v181,v177,s50
pm v223,v189,v185,s50
v_mfma_f32_16x16x16_bf16 v[248:251], v[216:217], v[144:145], v[248:251]
pm v224,v165,v161,s51
pm v225,v173,v169,s51
v_mfma_f32_16x16x16_bf16 v[252:255], v[218:219], v[144:145], v[252:255]
pm v226,v181,v177,s51
pm v227,v189,v185,s51
cv v16,v232,v236
cv v17,v233,v237
cv v18,v234,v238
cv v19,v235,v239
mf v[232:235],v[220:223],v[128:131],0
ds_write_b128 v14, v[16:19] offset:49152
cv v20,v240,v244
mf v[236:239],v[224:227],v[128:131],0
cv v21,v241,v245
cv v22,v242,v246
cv v23,v243,v247
mf v[240:243],v[220:223],v[132:135],0
cv v24,v248,v252
cv v25,v249,v253
mf v[244:247],v[224:227],v[132:135],0
cv v26,v250,v254
ds_write_b128 v14, v[20:23] offset:50176
cv v27,v251,v255
mf v[248:251],v[220:223],v[136:139],0
pm v228,v197,v193,s50
pm v229,v205,v201,s50
mf v[252:255],v[224:227],v[136:139],0
pm v230,v197,v193,s51
pm v231,v205,v201,s51
v_mfma_f32_16x16x16_bf16 v[232:235], v[228:229], v[140:141], v[232:235]
pm v208,v166,v162,s50
pm v209,v174,v170,s50
v_mfma_f32_16x16x16_bf16 v[236:239], v[230:231], v[140:141], v[236:239]
ds_write_b128 v14, v[24:27] offset:51200
pm v210,v182,v178,s50
v_mfma_f32_16x16x16_bf16 v[240:243], v[228:229], v[142:143], v[240:243]
pm v211,v190,v186,s50
pm v212,v166,v162,s51
v_mfma_f32_16x16x16_bf16 v[244:247], v[230:231], v[142:143], v[244:247]
pm v213,v174,v170,s51
pm v214,v182,v178,s51
v_mfma_f32_16x16x16_bf16 v[248:251], v[228:229], v[144:145], v[248:251]
pm v215,v190,v186,s51
cv v28,v232,v236
v_mfma_f32_16x16x16_bf16 v[252:255], v[230:231], v[144:145], v[252:255]
cv v29,v233,v237
cv v30,v234,v238
cv v31,v235,v239
mf v[232:235],v[208:211],v[128:131],0
ds_write_b128 v14, v[28:31] offset:52224
cv v16,v240,v244
mf v[236:239],v[212:215],v[128:131],0
cv v17,v241,v245
cv v18,v242,v246
cv v19,v243,v247
mf v[240:243],v[208:211],v[132:135],0
cv v20,v248,v252
cv v21,v249,v253
mf v[244:247],v[212:215],v[132:135],0
cv v22,v250,v254
ds_write_b128 v14, v[16:19] offset:53248
cv v23,v251,v255
mf v[248:251],v[208:211],v[136:139],0
pm v216,v198,v194,s50
pm v217,v206,v202,s50
mf v[252:255],v[212:215],v[136:139],0
pm v218,v198,v194,s51
pm v219,v206,v202,s51
v_mfma_f32_16x16x16_bf16 v[232:235], v[216:217], v[140:141], v[232:235]
pm v220,v167,v163,s50
pm v221,v175,v171,s50
v_mfma_f32_16x16x16_bf16 v[236:239], v[218:219], v[140:141], v[236:239]
ds_write_b128 v14, v[20:23] offset:54272
pm v222,v183,v179,s50
v_mfma_f32_16x16x16_bf16 v[240:243], v[216:217], v[142:143], v[240:243]
pm v223,v191,v187,s50
pm v224,v167,v163,s51
v_mfma_f32_16x16x16_bf16 v[244:247], v[218:219], v[142:143], v[244:247]
pm v225,v175,v171,s51
pm v226,v183,v179,s51
v_mfma_f32_16x16x16_bf16 v[248:251], v[216:217], v[144:145], v[248:251]
pm v227,v191,v187,s51
cv v24,v232,v236
v_mfma_f32_16x16x16_bf16 v[252:255], v[218:219], v[144:145], v[252:255]
cv v25,v233,v237
cv v26,v234,v238
cv v27,v235,v239
mf v[232:235],v[220:223],v[128:131],0
ds_write_b128 v14, v[24:27] offset:55296
cv v28,v240,v244
mf v[236:239],v[224:227],v[128:131],0
cv v29,v241,v245
cv v30,v242,v246
cv v31,v243,v247
mf v[240:243],v[220:223],v[132:135],0
cv v16,v248,v252
cv v17,v249,v253
mf v[244:247],v[224:227],v[132:135],0
cv v18,v250,v254
ds_write_b128 v14, v[28:31] offset:56320
cv v19,v251,v255
mf v[248:251],v[220:223],v[136:139],0
pm v228,v199,v195,s50
pm v229,v207,v203,s50
mf v[252:255],v[224:227],v[136:139],0
pm v230,v199,v195,s51
pm v231,v207,v203,s51
v_mfma_f32_16x16x16_bf16 v[232:235], v[228:229], v[140:141], v[232:235]
v_add_u32 v2, s100, v15
buffer_load_dwordx4 v[96:99], v2, s[16:19], 0 offen
v_mfma_f32_16x16x16_bf16 v[236:239], v[230:231], v[140:141], v[236:239]
ds_write_b128 v14, v[16:19] offset:57344
v_mfma_f32_16x16x16_bf16 v[240:243], v[228:229], v[142:143], v[240:243]
v_mfma_f32_16x16x16_bf16 v[244:247], v[230:231], v[142:143], v[244:247]
s_nop 4
cv v20,v232,v236
cv v21,v233,v237
v_mfma_f32_16x16x16_bf16 v[248:251], v[228:229], v[144:145], v[248:251]
cv v22,v234,v238
cv v23,v235,v239
v_mfma_f32_16x16x16_bf16 v[252:255], v[230:231], v[144:145], v[252:255]
buffer_load_dwordx4 v[100:103], v2, s[16:19], 0 offen offset:1024
ds_write_b128 v14, v[20:23] offset:58368
cv v24,v240,v244
cv v25,v241,v245
cv v26,v242,v246
cv v27,v243,v247
s_nop 1
cv v28,v248,v252
cv v29,v249,v253
cv v30,v250,v254
cv v31,v251,v255
ds_write_b128 v14, v[24:27] offset:59392
buffer_load_dwordx4 v[104:107], v2, s[16:19], s36 offen
ds_write_b128 v14, v[28:31] offset:60416
buffer_load_dwordx4 v[108:111], v2, s[16:19], s36 offen offset:1024
buffer_load_dwordx4 v[112:115], v2, s[16:19], s37 offen
buffer_load_dwordx4 v[116:119], v2, s[16:19], s37 offen offset:1024
buffer_load_dwordx4 v[120:123], v2, s[16:19], s38 offen
buffer_load_dwordx4 v[124:127], v2, s[16:19], s38 offen offset:1024
s_waitcnt lgkmcnt(0)
s_barrier
s_add_u32 s101, s94, s96
v_add_u32 v3, s101, v13
ds_read_b128 a[192:195], v3 offset:0
ds_read_b128 a[196:199], v3 offset:1024
ds_read_b128 a[200:203], v3 offset:2048
ds_read_b128 a[204:207], v3 offset:12288
ds_read_b128 a[208:211], v3 offset:13312
ds_read_b128 a[212:215], v3 offset:14336
pm v16,v36,v32,s50
pm v17,v44,v40,s50
pm v18,v52,v48,s50
pm v19,v60,v56,s50
pm v20,v36,v32,s51
pm v21,v44,v40,s51
pm v22,v52,v48,s51
pm v23,v60,v56,s51
s_waitcnt lgkmcnt(5)
mf a[0:3],a[192:195],v[16:19],a[0:3]
pm v24,v37,v33,s50
s_add_u32 s100, s88, s93
s_waitcnt lgkmcnt(4)
mf a[32:35],a[196:199],v[16:19],a[32:35]
v_add_u32 v2, s100, v15
buffer_load_dwordx4 v[128:131], v2, s[16:19], 0 offen
s_waitcnt lgkmcnt(3)
mf a[64:67],a[200:203],v[16:19],a[64:67]
pm v25,v45,v41,s50
s_waitcnt lgkmcnt(2)
mf a[96:99],a[204:207],v[16:19],a[96:99]
s_add_u32 s101, s94, s97
v_add_u32 v3, s101, v13
s_waitcnt lgkmcnt(1)
mf a[128:131],a[208:211],v[16:19],a[128:131]
ds_read_b128 a[216:219], v3 offset:0
pm v26,v53,v49,s50
s_waitcnt lgkmcnt(1)
mf a[160:163],a[212:215],v[16:19],a[160:163]
buffer_load_dwordx4 v[132:135], v2, s[16:19], 0 offen offset:1024
mf a[4:7],a[192:195],v[20:23],a[4:7]
pm v27,v61,v57,s50
pm v28,v37,v33,s51
mf a[36:39],a[196:199],v[20:23],a[36:39]
buffer_load_dwordx4 v[136:139], v2, s[16:19], s36 offen
pm v29,v45,v41,s51
mf a[68:71],a[200:203],v[20:23],a[68:71]
ds_read_b128 a[220:223], v3 offset:1024
mf a[100:103],a[204:207],v[20:23],a[100:103]
pm v30,v53,v49,s51
buffer_load_dwordx4 v[140:143], v2, s[16:19], s36 offen offset:1024
mf a[132:135],a[208:211],v[20:23],a[132:135]
pm v31,v61,v57,s51
mf a[164:167],a[212:215],v[20:23],a[164:167]
mf a[8:11],a[192:195],v[24:27],a[8:11]
pm v16,v38,v34,s50
pm v17,v46,v42,s50
mf a[40:43],a[196:199],v[24:27],a[40:43]
buffer_load_dwordx4 v[144:147], v2, s[16:19], s37 offen
mf a[72:75],a[200:203],v[24:27],a[72:75]
ds_read_b128 a[224:227], v3 offset:2048
mf a[104:107],a[204:207],v[24:27],a[104:107]
pm v18,v54,v50,s50
mf a[136:139],a[208:211],v[24:27],a[136:139]
pm v19,v62,v58,s50
mf a[168:171],a[212:215],v[24:27],a[168:171]
pm v20,v38,v34,s51
mf a[12:15],a[192:195],v[28:31],a[12:15]
pm v21,v46,v42,s51
mf a[44:47],a[196:199],v[28:31],a[44:47]
buffer_load_dwordx4 v[148:151], v2, s[16:19], s37 offen offset:1024
mf a[76:79],a[200:203],v[28:31],a[76:79]
ds_read_b128 a[228:231], v3 offset:12288
mf a[108:111],a[204:207],v[28:31],a[108:111]
pm v22,v54,v50,s51
mf a[140:143],a[208:211],v[28:31],a[140:143]
pm v23,v62,v58,s51
mf a[172:175],a[212:215],v[28:31],a[172:175]
mf a[16:19],a[192:195],v[16:19],a[16:19]
pm v24,v39,v35,s50
buffer_load_dwordx4 v[152:155], v2, s[16:19], s38 offen
mf a[48:51],a[196:199],v[16:19],a[48:51]
pm v25,v47,v43,s50
ds_read_b128 a[232:235], v3 offset:13312
mf a[80:83],a[200:203],v[16:19],a[80:83]
buffer_load_dwordx4 v[156:159], v2, s[16:19], s38 offen offset:1024
mf a[112:115],a[204:207],v[16:19],a[112:115]
pm v26,v55,v51,s50
pm v27,v63,v59,s50
mf a[144:147],a[208:211],v[16:19],a[144:147]
s_add_u32 s100, s89, s90
mf a[176:179],a[212:215],v[16:19],a[176:179]
v_add_u32 v2, s100, v15
buffer_load_dwordx4 v[160:163], v2, s[16:19], 0 offen
mf a[20:23],a[192:195],v[20:23],a[20:23]
pm v28,v39,v35,s51
mf a[52:55],a[196:199],v[20:23],a[52:55]
pm v29,v47,v43,s51
buffer_load_dwordx4 v[164:167], v2, s[16:19], 0 offen offset:1024
mf a[84:87],a[200:203],v[20:23],a[84:87]
ds_read_b128 a[236:239], v3 offset:14336
mf a[116:119],a[204:207],v[20:23],a[116:119]
pm v30,v55,v51,s51
buffer_load_dwordx4 v[168:171], v2, s[16:19], s36 offen
mf a[148:151],a[208:211],v[20:23],a[148:151]
pm v31,v63,v59,s51
mf a[180:183],a[212:215],v[20:23],a[180:183]
mf a[24:27],a[192:195],v[24:27],a[24:27]
s_waitcnt vmcnt(25)
pm v16,v68,v64,s50
buffer_load_dwordx4 v[172:175], v2, s[16:19], s36 offen offset:1024
mf a[56:59],a[196:199],v[24:27],a[56:59]
s_waitcnt vmcnt(24)
pm v17,v76,v72,s50
mf a[88:91],a[200:203],v[24:27],a[88:91]
buffer_load_dwordx4 v[176:179], v2, s[16:19], s37 offen
mf a[120:123],a[204:207],v[24:27],a[120:123]
s_waitcnt vmcnt(23)
pm v18,v84,v80,s50
mf a[152:155],a[208:211],v[24:27],a[152:155]
s_waitcnt vmcnt(21)
pm v19,v92,v88,s50
mf a[184:187],a[212:215],v[24:27],a[184:187]
buffer_load_dwordx4 v[180:183], v2, s[16:19], s37 offen offset:1024
pm v20,v68,v64,s51
mf a[28:31],a[192:195],v[28:31],a[28:31]
pm v21,v76,v72,s51
mf a[60:63],a[196:199],v[28:31],a[60:63]
buffer_load_dwordx4 v[184:187], v2, s[16:19], s38 offen
mf a[92:95],a[200:203],v[28:31],a[92:95]
pm v22,v84,v80,s51
mf a[124:127],a[204:207],v[28:31],a[124:127]
buffer_load_dwordx4 v[188:191], v2, s[16:19], s38 offen offset:1024
mf a[156:159],a[208:211],v[28:31],a[156:159]
pm v23,v92,v88,s51
mf a[188:191],a[212:215],v[28:31],a[188:191]
s_waitcnt lgkmcnt(5)
mf a[0:3],a[216:219],v[16:19],a[0:3]
pm v24,v69,v65,s50
s_add_u32 s100, s89, s91
v_add_u32 v2, s100, v15
s_waitcnt lgkmcnt(4)
mf a[32:35],a[220:223],v[16:19],a[32:35]
buffer_load_dwordx4 v[208:211], v2, s[16:19], 0 offen
pm v25,v77,v73,s50
s_add_u32 s101, s94, s99
s_waitcnt lgkmcnt(3)
mf a[64:67],a[224:227],v[16:19],a[64:67]
v_add_u32 v9, s101, v13
s_add_u32 s101, s95, s96
v_add_u32 v10, s101, v13
s_waitcnt lgkmcnt(2)
mf a[96:99],a[228:231],v[16:19],a[96:99]
s_add_u32 s101, s95, s97
v_add_u32 v11, s101, v13
s_add_u32 s101, s95, s98
s_waitcnt lgkmcnt(1)
mf a[128:131],a[232:235],v[16:19],a[128:131]
v_add_u32 v4, s101, v13
s_add_u32 s101, s95, s99
v_add_u32 v5, s101, v13
s_waitcnt lgkmcnt(0)
mf a[160:163],a[236:239],v[16:19],a[160:163]
ds_read_b128 a[240:243], v9 offset:0
ds_read_b128 a[244:247], v9 offset:1024
ds_read_b128 a[248:251], v10 offset:0
mf a[4:7],a[216:219],v[20:23],a[4:7]
ds_read_b128 a[252:255], v10 offset:1024
s_add_u32 s101, s94, s98
v_add_u32 v3, s101, v13
mf a[36:39],a[220:223],v[20:23],a[36:39]
ds_read_b128 a[192:195], v3 offset:0
pm v26,v85,v81,s50
buffer_load_dwordx4 v[212:215], v2, s[16:19], 0 offen offset:1024
mf a[68:71],a[224:227],v[20:23],a[68:71]
pm v27,v93,v89,s50
pm v28,v69,v65,s51
buffer_load_dwordx4 v[216:219], v2, s[16:19], s36 offen
mf a[100:103],a[228:231],v[20:23],a[100:103]
pm v29,v77,v73,s51
buffer_load_dwordx4 v[220:223], v2, s[16:19], s36 offen offset:1024
ds_read_b128 a[196:199], v3 offset:1024
mf a[132:135],a[232:235],v[20:23],a[132:135]
pm v30,v85,v81,s51
buffer_load_dwordx4 v[224:227], v2, s[16:19], s37 offen
pm v31,v93,v89,s51
mf a[164:167],a[236:239],v[20:23],a[164:167]
mf a[8:11],a[216:219],v[24:27],a[8:11]
pm v16,v70,v66,s50
buffer_load_dwordx4 v[228:231], v2, s[16:19], s37 offen offset:1024
mf a[40:43],a[220:223],v[24:27],a[40:43]
pm v17,v78,v74,s50
s_waitcnt vmcnt(28)
pm v192,v102,v98,s50
mf a[72:75],a[224:227],v[24:27],a[72:75]
s_waitcnt vmcnt(26)
pm v193,v110,v106,s50
s_waitcnt vmcnt(24)
pm v194,v118,v114,s50
mf a[104:107],a[228:231],v[24:27],a[104:107]
s_waitcnt vmcnt(22)
pm v195,v126,v122,s50
ds_read_b128 a[200:203], v3 offset:2048
mf a[136:139],a[232:235],v[24:27],a[136:139]
pm v18,v86,v82,s50
buffer_load_dwordx4 v[232:235], v2, s[16:19], s38 offen
mf a[168:171],a[236:239],v[24:27],a[168:171]
pm v19,v94,v90,s50
pm v20,v70,v66,s51
mf a[12:15],a[216:219],v[28:31],a[12:15]
buffer_load_dwordx4 v[236:239], v2, s[16:19], s38 offen offset:1024
pm v21,v78,v74,s51
mf a[44:47],a[220:223],v[28:31],a[44:47]
s_add_u32 s100, s89, s92
v_add_u32 v2, s100, v15
mf a[76:79],a[224:227],v[28:31],a[76:79]
buffer_load_dwordx4 v[32:35], v2, s[16:19], 0 offen
ds_read_b128 a[204:207], v3 offset:12288
mf a[108:111],a[228:231],v[28:31],a[108:111]
pm v22,v86,v82,s51
buffer_load_dwordx4 v[36:39], v2, s[16:19], 0 offen offset:1024
mf a[140:143],a[232:235],v[28:31],a[140:143]
pm v23,v94,v90,s51
mf a[172:175],a[236:239],v[28:31],a[172:175]
mf a[16:19],a[216:219],v[16:19],a[16:19]
pm v24,v71,v67,s50
buffer_load_dwordx4 v[40:43], v2, s[16:19], s36 offen
mf a[48:51],a[220:223],v[16:19],a[48:51]
pm v25,v79,v75,s50
pm v196,v102,v98,s51
mf a[80:83],a[224:227],v[16:19],a[80:83]
pm v197,v110,v106,s51
pm v198,v118,v114,s51
mf a[112:115],a[228:231],v[16:19],a[112:115]
pm v199,v126,v122,s51
mf a[144:147],a[232:235],v[16:19],a[144:147]
ds_read_b128 a[208:211], v3 offset:13312
pm v26,v87,v83,s50
mf a[176:179],a[236:239],v[16:19],a[176:179]
buffer_load_dwordx4 v[44:47], v2, s[16:19], s36 offen offset:1024
pm v27,v95,v91,s50
mf a[20:23],a[216:219],v[20:23],a[20:23]
pm v28,v71,v67,s51
buffer_load_dwordx4 v[48:51], v2, s[16:19], s37 offen
mf a[52:55],a[220:223],v[20:23],a[52:55]
pm v29,v79,v75,s51
mf a[84:87],a[224:227],v[20:23],a[84:87]
buffer_load_dwordx4 v[52:55], v2, s[16:19], s37 offen offset:1024
ds_read_b128 a[212:215], v3 offset:14336
mf a[116:119],a[228:231],v[20:23],a[116:119]
pm v30,v87,v83,s51
buffer_load_dwordx4 v[56:59], v2, s[16:19], s38 offen
mf a[148:151],a[232:235],v[20:23],a[148:151]
pm v31,v95,v91,s51
mf a[180:183],a[236:239],v[20:23],a[180:183]
mf a[24:27],a[216:219],v[24:27],a[24:27]
pm v16,v100,v96,s50
buffer_load_dwordx4 v[60:63], v2, s[16:19], s38 offen offset:1024
mf a[56:59],a[220:223],v[24:27],a[56:59]
pm v17,v108,v104,s50
pm v200,v103,v99,s50
mf a[88:91],a[224:227],v[24:27],a[88:91]
pm v201,v111,v107,s50
pm v202,v119,v115,s50
mf a[120:123],a[228:231],v[24:27],a[120:123]
pm v203,v127,v123,s50
pm v18,v116,v112,s50
mf a[152:155],a[232:235],v[24:27],a[152:155]
pm v19,v124,v120,s50
pm v204,v103,v99,s51
mf a[184:187],a[236:239],v[24:27],a[184:187]
pm v205,v111,v107,s51
pm v206,v119,v115,s51
mf a[28:31],a[216:219],v[28:31],a[28:31]
pm v207,v127,v123,s51
pm v20,v100,v96,s51
mf a[60:63],a[220:223],v[28:31],a[60:63]
pm v21,v108,v104,s51
s_add_u32 s100, s89, s93
mf a[92:95],a[224:227],v[28:31],a[92:95]
v_add_u32 v2, s100, v15
buffer_load_dwordx4 v[64:67], v2, s[16:19], 0 offen
mf a[124:127],a[228:231],v[28:31],a[124:127]
pm v22,v116,v112,s51
buffer_load_dwordx4 v[68:71], v2, s[16:19], 0 offen offset:1024
mf a[156:159],a[232:235],v[28:31],a[156:159]
pm v23,v124,v120,s51
mf a[188:191],a[236:239],v[28:31],a[188:191]
s_waitcnt lgkmcnt(5)
mf a[0:3],a[192:195],v[16:19],a[0:3]
ds_read_b128 a[216:219], v11 offset:0
buffer_load_dwordx4 v[72:75], v2, s[16:19], s36 offen
s_waitcnt lgkmcnt(5)
mf a[32:35],a[196:199],v[16:19],a[32:35]
ds_read_b128 a[220:223], v11 offset:1024
pm v24,v101,v97,s50
mf a[4:7],a[192:195],v[20:23],a[4:7]
ds_read_b128 a[224:227], v4 offset:0
pm v25,v109,v105,s50
mf a[36:39],a[196:199],v[20:23],a[36:39]
ds_read_b128 a[228:231], v4 offset:1024
pm v26,v117,v113,s50
pm v27,v125,v121,s50
pm v28,v101,v97,s51
ds_read_b128 a[232:235], v5 offset:0
mf a[8:11],a[192:195],v[24:27],a[8:11]
buffer_load_dwordx4 v[76:79], v2, s[16:19], s36 offen offset:1024
ds_read_b128 a[236:239], v5 offset:1024
mf a[40:43],a[196:199],v[24:27],a[40:43]
pm v29,v109,v105,s51
pm v30,v117,v113,s51
pm v31,v125,v121,s51
s_waitcnt vmcnt(34)
pm v96,v132,v128,s50
s_waitcnt vmcnt(32)
pm v97,v140,v136,s50
mf a[12:15],a[192:195],v[28:31],a[12:15]
s_waitcnt vmcnt(30)
pm v98,v148,v144,s50
s_waitcnt vmcnt(28)
pm v99,v156,v152,s50
mf a[44:47],a[196:199],v[28:31],a[44:47]
pm v100,v132,v128,s51
pm v101,v140,v136,s51
mf a[16:19],a[192:195],v[192:195],a[16:19]
buffer_load_dwordx4 v[80:83], v2, s[16:19], s37 offen
pm v102,v148,v144,s51
mf a[48:51],a[196:199],v[192:195],a[48:51]
pm v103,v156,v152,s51
pm v104,v133,v129,s50
mf a[20:23],a[192:195],v[196:199],a[20:23]
pm v105,v141,v137,s50
pm v106,v149,v145,s50
mf a[52:55],a[196:199],v[196:199],a[52:55]
pm v107,v157,v153,s50
pm v108,v133,v129,s51
mf a[24:27],a[192:195],v[200:203],a[24:27]
pm v109,v141,v137,s51
buffer_load_dwordx4 v[84:87], v2, s[16:19], s37 offen offset:1024
mf a[56:59],a[196:199],v[200:203],a[56:59]
pm v110,v149,v145,s51
pm v111,v157,v153,s51
mf a[28:31],a[192:195],v[204:207],a[28:31]
pm v112,v134,v130,s50
pm v113,v142,v138,s50
mf a[60:63],a[196:199],v[204:207],a[60:63]
pm v114,v150,v146,s50
pm v115,v158,v154,s50
mf a[0:3],a[240:243],v[96:99],a[0:3]
pm v116,v134,v130,s51
pm v117,v142,v138,s51
mf a[32:35],a[244:247],v[96:99],a[32:35]
buffer_load_dwordx4 v[88:91], v2, s[16:19], s38 offen
pm v118,v150,v146,s51
mf a[4:7],a[240:243],v[100:103],a[4:7]
pm v119,v158,v154,s51
pm v120,v135,v131,s50
mf a[36:39],a[244:247],v[100:103],a[36:39]
pm v121,v143,v139,s50
pm v122,v151,v147,s50
mf a[8:11],a[240:243],v[104:107],a[8:11]
pm v123,v159,v155,s50
pm v124,v135,v131,s51
mf a[40:43],a[244:247],v[104:107],a[40:43]
pm v125,v143,v139,s51
buffer_load_dwordx4 v[92:95], v2, s[16:19], s38 offen offset:1024
mf a[12:15],a[240:243],v[108:111],a[12:15]
pm v126,v151,v147,s51
pm v127,v159,v155,s51
mf a[44:47],a[244:247],v[108:111],a[44:47]
s_waitcnt vmcnt(30)
pm v128,v164,v160,s50
s_waitcnt vmcnt(28)
pm v129,v172,v168,s50
mf a[16:19],a[240:243],v[112:115],a[16:19]
s_waitcnt vmcnt(26)
pm v130,v180,v176,s50
s_waitcnt vmcnt(24)
pm v131,v188,v184,s50
mf a[48:51],a[244:247],v[112:115],a[48:51]
pm v132,v164,v160,s51
pm v133,v172,v168,s51
mf a[20:23],a[240:243],v[116:119],a[20:23]
pm v134,v180,v176,s51
pm v135,v188,v184,s51
mf a[52:55],a[244:247],v[116:119],a[52:55]
pm v136,v165,v161,s50
pm v137,v173,v169,s50
mf a[24:27],a[240:243],v[120:123],a[24:27]
pm v138,v181,v177,s50
pm v139,v189,v185,s50
mf a[56:59],a[244:247],v[120:123],a[56:59]
pm v140,v165,v161,s51
pm v141,v173,v169,s51
mf a[28:31],a[240:243],v[124:127],a[28:31]
ds_read_b128 a[240:243], v9 offset:2048
pm v142,v181,v177,s51
mf a[60:63],a[244:247],v[124:127],a[60:63]
ds_read_b128 a[244:247], v10 offset:2048
pm v143,v189,v185,s51
mf a[0:3],a[248:251],v[128:131],a[0:3]
pm v144,v166,v162,s50
pm v145,v174,v170,s50
mf a[32:35],a[252:255],v[128:131],a[32:35]
pm v146,v182,v178,s50
pm v147,v190,v186,s50
mf a[4:7],a[248:251],v[132:135],a[4:7]
pm v148,v166,v162,s51
pm v149,v174,v170,s51
mf a[36:39],a[252:255],v[132:135],a[36:39]
pm v150,v182,v178,s51
pm v151,v190,v186,s51
mf a[8:11],a[248:251],v[136:139],a[8:11]
pm v152,v167,v163,s50
pm v153,v175,v171,s50
mf a[40:43],a[252:255],v[136:139],a[40:43]
pm v154,v183,v179,s50
pm v155,v191,v187,s50
mf a[12:15],a[248:251],v[140:143],a[12:15]
pm v156,v167,v163,s51
pm v157,v175,v171,s51
mf a[44:47],a[252:255],v[140:143],a[44:47]
pm v158,v183,v179,s51
pm v159,v191,v187,s51
mf a[16:19],a[248:251],v[144:147],a[16:19]
s_waitcnt vmcnt(22)
pm v160,v212,v208,s50
s_waitcnt vmcnt(20)
pm v161,v220,v216,s50
mf a[48:51],a[252:255],v[144:147],a[48:51]
s_waitcnt vmcnt(18)
pm v162,v228,v224,s50
s_waitcnt vmcnt(16)
pm v163,v236,v232,s50
mf a[20:23],a[248:251],v[148:151],a[20:23]
pm v164,v212,v208,s51
pm v165,v220,v216,s51
mf a[52:55],a[252:255],v[148:151],a[52:55]
pm v166,v228,v224,s51
pm v167,v236,v232,s51
mf a[24:27],a[248:251],v[152:155],a[24:27]
pm v168,v213,v209,s50
pm v169,v221,v217,s50
mf a[56:59],a[252:255],v[152:155],a[56:59]
pm v170,v229,v225,s50
pm v171,v237,v233,s50
mf a[28:31],a[248:251],v[156:159],a[28:31]
ds_read_b128 a[248:251], v11 offset:2048
pm v172,v213,v209,s51
mf a[60:63],a[252:255],v[156:159],a[60:63]
ds_read_b128 a[252:255], v4 offset:2048
pm v173,v221,v217,s51
s_waitcnt lgkmcnt(9)
mf a[0:3],a[216:219],v[160:163],a[0:3]
pm v174,v229,v225,s51
pm v175,v237,v233,s51
s_waitcnt lgkmcnt(8)
mf a[32:35],a[220:223],v[160:163],a[32:35]
pm v176,v214,v210,s50
pm v177,v222,v218,s50
mf a[4:7],a[216:219],v[164:167],a[4:7]
pm v178,v230,v226,s50
pm v179,v238,v234,s50
mf a[36:39],a[220:223],v[164:167],a[36:39]
pm v180,v214,v210,s51
pm v181,v222,v218,s51
mf a[8:11],a[216:219],v[168:171],a[8:11]
pm v182,v230,v226,s51
pm v183,v238,v234,s51
mf a[40:43],a[220:223],v[168:171],a[40:43]
pm v184,v215,v211,s50
pm v185,v223,v219,s50
mf a[12:15],a[216:219],v[172:175],a[12:15]
pm v186,v231,v227,s50
pm v187,v239,v235,s50
mf a[44:47],a[220:223],v[172:175],a[44:47]
pm v188,v215,v211,s51
pm v189,v223,v219,s51
mf a[16:19],a[216:219],v[176:179],a[16:19]
pm v190,v231,v227,s51
pm v191,v239,v235,s51
mf a[48:51],a[220:223],v[176:179],a[48:51]
s_waitcnt vmcnt(14)
pm v208,v36,v32,s50
s_waitcnt vmcnt(12)
pm v209,v44,v40,s50
mf a[20:23],a[216:219],v[180:183],a[20:23]
s_waitcnt vmcnt(10)
pm v210,v52,v48,s50
s_waitcnt vmcnt(8)
pm v211,v60,v56,s50
mf a[52:55],a[220:223],v[180:183],a[52:55]
pm v212,v36,v32,s51
pm v213,v44,v40,s51
mf a[24:27],a[216:219],v[184:187],a[24:27]
pm v214,v52,v48,s51
pm v215,v60,v56,s51
mf a[56:59],a[220:223],v[184:187],a[56:59]
pm v216,v37,v33,s50
pm v217,v45,v41,s50
mf a[28:31],a[216:219],v[188:191],a[28:31]
ds_read_b128 a[216:219], v5 offset:2048
pm v218,v53,v49,s50
mf a[60:63],a[220:223],v[188:191],a[60:63]
ds_read_b128 a[220:223], v9 offset:12288
pm v219,v61,v57,s50
s_waitcnt lgkmcnt(9)
mf a[0:3],a[224:227],v[208:211],a[0:3]
pm v220,v37,v33,s51
pm v221,v45,v41,s51
s_waitcnt lgkmcnt(8)
mf a[32:35],a[228:231],v[208:211],a[32:35]
pm v222,v53,v49,s51
pm v223,v61,v57,s51
mf a[4:7],a[224:227],v[212:215],a[4:7]
pm v224,v38,v34,s50
pm v225,v46,v42,s50
mf a[36:39],a[228:231],v[212:215],a[36:39]
pm v226,v54,v50,s50
pm v227,v62,v58,s50
mf a[8:11],a[224:227],v[216:219],a[8:11]
pm v228,v38,v34,s51
pm v229,v46,v42,s51
mf a[40:43],a[228:231],v[216:219],a[40:43]
pm v230,v54,v50,s51
pm v231,v62,v58,s51
mf a[12:15],a[224:227],v[220:223],a[12:15]
pm v232,v39,v35,s50
pm v233,v47,v43,s50
mf a[44:47],a[228:231],v[220:223],a[44:47]
pm v234,v55,v51,s50
pm v235,v63,v59,s50
mf a[16:19],a[224:227],v[224:227],a[16:19]
pm v236,v39,v35,s51
pm v237,v47,v43,s51
mf a[48:51],a[228:231],v[224:227],a[48:51]
pm v238,v55,v51,s51
pm v239,v63,v59,s51
mf a[20:23],a[224:227],v[228:231],a[20:23]
s_waitcnt vmcnt(6)
pm v32,v68,v64,s50
s_waitcnt vmcnt(4)
pm v33,v76,v72,s50
mf a[52:55],a[228:231],v[228:231],a[52:55]
s_waitcnt vmcnt(2)
pm v34,v84,v80,s50
s_waitcnt vmcnt(0)
pm v35,v92,v88,s50
mf a[24:27],a[224:227],v[232:235],a[24:27]
pm v36,v68,v64,s51
pm v37,v76,v72,s51
mf a[56:59],a[228:231],v[232:235],a[56:59]
pm v38,v84,v80,s51
pm v39,v92,v88,s51
mf a[28:31],a[224:227],v[236:239],a[28:31]
ds_read_b128 a[224:227], v10 offset:12288
pm v40,v69,v65,s50
mf a[60:63],a[228:231],v[236:239],a[60:63]
ds_read_b128 a[228:231], v11 offset:12288
pm v41,v77,v73,s50
s_waitcnt lgkmcnt(9)
mf a[0:3],a[232:235],v[32:35],a[0:3]
pm v42,v85,v81,s50
pm v43,v93,v89,s50
s_waitcnt lgkmcnt(8)
mf a[32:35],a[236:239],v[32:35],a[32:35]
pm v44,v69,v65,s51
pm v45,v77,v73,s51
mf a[4:7],a[232:235],v[36:39],a[4:7]
pm v46,v85,v81,s51
pm v47,v93,v89,s51
mf a[36:39],a[236:239],v[36:39],a[36:39]
pm v48,v70,v66,s50
pm v49,v78,v74,s50
mf a[8:11],a[232:235],v[40:43],a[8:11]
pm v50,v86,v82,s50
pm v51,v94,v90,s50
mf a[40:43],a[236:239],v[40:43],a[40:43]
pm v52,v70,v66,s51
pm v53,v78,v74,s51
mf a[12:15],a[232:235],v[44:47],a[12:15]
pm v54,v86,v82,s51
pm v55,v94,v90,s51
mf a[44:47],a[236:239],v[44:47],a[44:47]
pm v56,v71,v67,s50
pm v57,v79,v75,s50
mf a[16:19],a[232:235],v[48:51],a[16:19]
pm v58,v87,v83,s50
pm v59,v95,v91,s50
mf a[48:51],a[236:239],v[48:51],a[48:51]
pm v60,v71,v67,s51
pm v61,v79,v75,s51
mf a[20:23],a[232:235],v[52:55],a[20:23]
pm v62,v87,v83,s51
pm v63,v95,v91,s51
mf a[52:55],a[236:239],v[52:55],a[52:55]
ar v240,a0
ar v241,a4
mf a[24:27],a[232:235],v[56:59],a[24:27]
ar v242,a8
ar v243,a12
mf a[56:59],a[236:239],v[56:59],a[56:59]
ar v244,a16
ar v245,a20
mf a[28:31],a[232:235],v[60:63],a[28:31]
ds_read_b128 a[232:235], v4 offset:12288
s_nop 0
ar v246,a24
mf a[60:63],a[236:239],v[60:63],a[60:63]
ds_read_b128 a[236:239], v5 offset:12288
ar v248,a1
mf a[64:67],a[200:203],v[16:19],a[64:67]
s_nop 0
ar v247,a28
ar v249,a5
mf a[68:71],a[200:203],v[20:23],a[68:71]
ar v250,a9
ar v251,a13
mf a[72:75],a[200:203],v[24:27],a[72:75]
ar v252,a17
ar v253,a21
mf a[76:79],a[200:203],v[28:31],a[76:79]
ar v254,a25
ar v255,a29
mf a[80:83],a[200:203],v[192:195],a[80:83]
cv v64,v240,v241
cv v65,v242,v243
mf a[84:87],a[200:203],v[196:199],a[84:87]
cv v66,v244,v245
cv v67,v246,v247
mf a[88:91],a[200:203],v[200:203],a[88:91]
buffer_store_dwordx4 v[64:67], v7, s[28:31], 0 offen sc0 sc1
cv v68,v248,v249
mf a[92:95],a[200:203],v[204:207],a[92:95]
cv v69,v250,v251
cv v70,v252,v253
s_waitcnt lgkmcnt(9)
mf a[64:67],a[240:243],v[96:99],a[64:67]
cv v71,v254,v255
ar v240,a2
mf a[68:71],a[240:243],v[100:103],a[68:71]
ar v241,a6
ar v242,a10
mf a[72:75],a[240:243],v[104:107],a[72:75]
ar v243,a14
ar v244,a18
mf a[76:79],a[240:243],v[108:111],a[76:79]
ar v245,a22
ar v246,a26
mf a[80:83],a[240:243],v[112:115],a[80:83]
ar v247,a30
buffer_store_dwordx4 v[68:71], v7, s[28:31], 0 offen offset:1024 sc0 sc1
mf a[84:87],a[240:243],v[116:119],a[84:87]
ar v248,a3
ar v249,a7
mf a[88:91],a[240:243],v[120:123],a[88:91]
ar v250,a11
ar v251,a15
mf a[92:95],a[240:243],v[124:127],a[92:95]
ds_read_b128 a[240:243], v9 offset:13312
ar v252,a19
s_waitcnt lgkmcnt(9)
mf a[64:67],a[244:247],v[128:131],a[64:67]
ar v253,a23
ar v254,a27
mf a[68:71],a[244:247],v[132:135],a[68:71]
ar v255,a31
cv v72,v240,v241
mf a[72:75],a[244:247],v[136:139],a[72:75]
cv v73,v242,v243
cv v74,v244,v245
mf a[76:79],a[244:247],v[140:143],a[76:79]
cv v75,v246,v247
buffer_store_dwordx4 v[72:75], v7, s[28:31], 0 offen offset:2048 sc0 sc1
mf a[80:83],a[244:247],v[144:147],a[80:83]
cv v76,v248,v249
cv v77,v250,v251
mf a[84:87],a[244:247],v[148:151],a[84:87]
cv v78,v252,v253
cv v79,v254,v255
mf a[88:91],a[244:247],v[152:155],a[88:91]
ar v240,a32
ar v241,a36
mf a[92:95],a[244:247],v[156:159],a[92:95]
ds_read_b128 a[244:247], v10 offset:13312
ar v242,a40
s_waitcnt lgkmcnt(9)
mf a[64:67],a[248:251],v[160:163],a[64:67]
ar v243,a44
ar v244,a48
mf a[68:71],a[248:251],v[164:167],a[68:71]
ar v245,a52
ar v246,a56
mf a[72:75],a[248:251],v[168:171],a[72:75]
buffer_store_dwordx4 v[76:79], v7, s[28:31], 0 offen offset:3072 sc0 sc1
ar v247,a60
mf a[76:79],a[248:251],v[172:175],a[76:79]
ar v248,a33
ar v249,a37
mf a[80:83],a[248:251],v[176:179],a[80:83]
ar v250,a41
ar v251,a45
mf a[84:87],a[248:251],v[180:183],a[84:87]
ar v252,a49
ar v253,a53
mf a[88:91],a[248:251],v[184:187],a[88:91]
ar v254,a57
ar v255,a61
mf a[92:95],a[248:251],v[188:191],a[92:95]
ds_read_b128 a[248:251], v11 offset:13312
cv v80,v240,v241
s_waitcnt lgkmcnt(9)
mf a[64:67],a[252:255],v[208:211],a[64:67]
cv v81,v242,v243
cv v82,v244,v245
mf a[68:71],a[252:255],v[212:215],a[68:71]
cv v83,v246,v247
buffer_store_dwordx4 v[80:83], v7, s[28:31], s37 offen sc0 sc1
mf a[72:75],a[252:255],v[216:219],a[72:75]
cv v84,v248,v249
cv v85,v250,v251
mf a[76:79],a[252:255],v[220:223],a[76:79]
cv v86,v252,v253
cv v87,v254,v255
mf a[80:83],a[252:255],v[224:227],a[80:83]
ar v240,a34
ar v241,a38
mf a[84:87],a[252:255],v[228:231],a[84:87]
ar v242,a42
ar v243,a46
mf a[88:91],a[252:255],v[232:235],a[88:91]
ar v244,a50
ar v245,a54
mf a[92:95],a[252:255],v[236:239],a[92:95]
ds_read_b128 a[252:255], v4 offset:13312
ar v246,a58
s_waitcnt lgkmcnt(9)
mf a[64:67],a[216:219],v[32:35],a[64:67]
buffer_store_dwordx4 v[84:87], v7, s[28:31], s37 offen offset:1024 sc0 sc1
ar v247,a62
mf a[68:71],a[216:219],v[36:39],a[68:71]
ar v248,a35
ar v249,a39
mf a[72:75],a[216:219],v[40:43],a[72:75]
ar v250,a43
ar v251,a47
mf a[76:79],a[216:219],v[44:47],a[76:79]
ar v252,a51
ar v253,a55
mf a[80:83],a[216:219],v[48:51],a[80:83]
ar v254,a59
ar v255,a63
mf a[84:87],a[216:219],v[52:55],a[84:87]
cv v88,v240,v241
cv v89,v242,v243
mf a[88:91],a[216:219],v[56:59],a[88:91]
cv v90,v244,v245
cv v91,v246,v247
mf a[92:95],a[216:219],v[60:63],a[92:95]
ds_read_b128 a[216:219], v5 offset:13312
buffer_store_dwordx4 v[88:91], v7, s[28:31], s37 offen offset:2048 sc0 sc1
mf a[96:99],a[204:207],v[16:19],a[96:99]
cv v92,v248,v249
cv v93,v250,v251
mf a[100:103],a[204:207],v[20:23],a[100:103]
cv v94,v252,v253
cv v95,v254,v255
mf a[104:107],a[204:207],v[24:27],a[104:107]
ar v240,a64
ar v241,a68
mf a[108:111],a[204:207],v[28:31],a[108:111]
ar v242,a72
ar v243,a76
mf a[112:115],a[204:207],v[192:195],a[112:115]
ar v244,a80
ar v245,a84
mf a[116:119],a[204:207],v[196:199],a[116:119]
ar v246,a88
ar v247,a92
mf a[120:123],a[204:207],v[200:203],a[120:123]
buffer_store_dwordx4 v[92:95], v7, s[28:31], s37 offen offset:3072 sc0 sc1
ar v248,a65
mf a[124:127],a[204:207],v[204:207],a[124:127]
ar v249,a69
ar v250,a73
s_waitcnt lgkmcnt(9)
mf a[96:99],a[220:223],v[96:99],a[96:99]
ar v251,a77
ar v252,a81
mf a[100:103],a[220:223],v[100:103],a[100:103]
ar v253,a85
ar v254,a89
mf a[104:107],a[220:223],v[104:107],a[104:107]
ar v255,a93
cv v64,v240,v241
mf a[108:111],a[220:223],v[108:111],a[108:111]
cv v65,v242,v243
cv v66,v244,v245
mf a[112:115],a[220:223],v[112:115],a[112:115]
cv v67,v246,v247
buffer_store_dwordx4 v[64:67], v7, s[28:31], s39 offen sc0 sc1
mf a[116:119],a[220:223],v[116:119],a[116:119]
cv v68,v248,v249
cv v69,v250,v251
mf a[120:123],a[220:223],v[120:123],a[120:123]
cv v70,v252,v253
cv v71,v254,v255
mf a[124:127],a[220:223],v[124:127],a[124:127]
ds_read_b128 a[220:223], v9 offset:14336
ar v240,a66
s_waitcnt lgkmcnt(9)
mf a[96:99],a[224:227],v[128:131],a[96:99]
ar v241,a70
ar v242,a74
mf a[100:103],a[224:227],v[132:135],a[100:103]
ar v243,a78
ar v244,a82
mf a[104:107],a[224:227],v[136:139],a[104:107]
ar v245,a86
ar v246,a90
mf a[108:111],a[224:227],v[140:143],a[108:111]
buffer_store_dwordx4 v[68:71], v7, s[28:31], s39 offen offset:1024 sc0 sc1
ar v247,a94
mf a[112:115],a[224:227],v[144:147],a[112:115]
ar v248,a67
ar v249,a71
mf a[116:119],a[224:227],v[148:151],a[116:119]
ar v250,a75
ar v251,a79
mf a[120:123],a[224:227],v[152:155],a[120:123]
ar v252,a83
ar v253,a87
mf a[124:127],a[224:227],v[156:159],a[124:127]
ds_read_b128 a[224:227], v10 offset:14336
ar v254,a91
s_waitcnt lgkmcnt(9)
mf a[96:99],a[228:231],v[160:163],a[96:99]
ar v255,a95
cv v72,v240,v241
mf a[100:103],a[228:231],v[164:167],a[100:103]
cv v73,v242,v243
cv v74,v244,v245
mf a[104:107],a[228:231],v[168:171],a[104:107]
cv v75,v246,v247
buffer_store_dwordx4 v[72:75], v7, s[28:31], s39 offen offset:2048 sc0 sc1
mf a[108:111],a[228:231],v[172:175],a[108:111]
cv v76,v248,v249
cv v77,v250,v251
mf a[112:115],a[228:231],v[176:179],a[112:115]
cv v78,v252,v253
cv v79,v254,v255
mf a[116:119],a[228:231],v[180:183],a[116:119]
mf a[120:123],a[228:231],v[184:187],a[120:123]
mf a[124:127],a[228:231],v[188:191],a[124:127]
ds_read_b128 a[228:231], v11 offset:14336
s_waitcnt lgkmcnt(9)
mf a[96:99],a[232:235],v[208:211],a[96:99]
mf a[100:103],a[232:235],v[212:215],a[100:103]
buffer_store_dwordx4 v[76:79], v7, s[28:31], s39 offen offset:3072 sc0 sc1
mf a[104:107],a[232:235],v[216:219],a[104:107]
mf a[108:111],a[232:235],v[220:223],a[108:111]
mf a[112:115],a[232:235],v[224:227],a[112:115]
mf a[116:119],a[232:235],v[228:231],a[116:119]
mf a[120:123],a[232:235],v[232:235],a[120:123]
mf a[124:127],a[232:235],v[236:239],a[124:127]
ds_read_b128 a[232:235], v4 offset:14336
s_waitcnt lgkmcnt(9)
mf a[96:99],a[236:239],v[32:35],a[96:99]
mf a[100:103],a[236:239],v[36:39],a[100:103]
mf a[104:107],a[236:239],v[40:43],a[104:107]
s_nop 5
ar v240,a96
ar v248,a97
mf a[108:111],a[236:239],v[44:47],a[108:111]
ar v241,a100
ar v249,a101
mf a[112:115],a[236:239],v[48:51],a[112:115]
ar v242,a104
ar v250,a105
mf a[116:119],a[236:239],v[52:55],a[116:119]
s_nop 1
ar v243,a108
ar v251,a109
mf a[120:123],a[236:239],v[56:59],a[120:123]
ar v244,a112
ar v252,a113
mf a[124:127],a[236:239],v[60:63],a[124:127]
ds_read_b128 a[236:239], v5 offset:14336
ar v245,a116
mf a[128:131],a[208:211],v[16:19],a[128:131]
s_nop 1
ar v246,a120
ar v253,a117
mf a[132:135],a[208:211],v[20:23],a[132:135]
ar v247,a124
ar v254,a121
mf a[136:139],a[208:211],v[24:27],a[136:139]
ar v255,a125
cv v80,v240,v241
mf a[140:143],a[208:211],v[28:31],a[140:143]
cv v81,v242,v243
cv v82,v244,v245
mf a[144:147],a[208:211],v[192:195],a[144:147]
cv v83,v246,v247
buffer_store_dwordx4 v[80:83], v7, s[28:31], s41 offen sc0 sc1
mf a[148:151],a[208:211],v[196:199],a[148:151]
cv v84,v248,v249
cv v85,v250,v251
mf a[152:155],a[208:211],v[200:203],a[152:155]
cv v86,v252,v253
cv v87,v254,v255
mf a[156:159],a[208:211],v[204:207],a[156:159]
ar v240,a98
ar v241,a102
s_waitcnt lgkmcnt(9)
mf a[128:131],a[240:243],v[96:99],a[128:131]
ar v242,a106
ar v243,a110
mf a[132:135],a[240:243],v[100:103],a[132:135]
ar v244,a114
ar v245,a118
mf a[136:139],a[240:243],v[104:107],a[136:139]
ar v246,a122
ar v247,a126
mf a[140:143],a[240:243],v[108:111],a[140:143]
buffer_store_dwordx4 v[84:87], v7, s[28:31], s41 offen offset:1024 sc0 sc1
ar v248,a99
mf a[144:147],a[240:243],v[112:115],a[144:147]
ar v249,a103
ar v250,a107
mf a[148:151],a[240:243],v[116:119],a[148:151]
ar v251,a111
ar v252,a115
mf a[152:155],a[240:243],v[120:123],a[152:155]
ar v253,a119
ar v254,a123
mf a[156:159],a[240:243],v[124:127],a[156:159]
ar v255,a127
cv v88,v240,v241
s_waitcnt lgkmcnt(8)
mf a[128:131],a[244:247],v[128:131],a[128:131]
cv v89,v242,v243
cv v90,v244,v245
mf a[132:135],a[244:247],v[132:135],a[132:135]
cv v91,v246,v247
buffer_store_dwordx4 v[88:91], v7, s[28:31], s41 offen offset:2048 sc0 sc1
mf a[136:139],a[244:247],v[136:139],a[136:139]
cv v92,v248,v249
cv v93,v250,v251
mf a[140:143],a[244:247],v[140:143],a[140:143]
cv v94,v252,v253
cv v95,v254,v255
mf a[144:147],a[244:247],v[144:147],a[144:147]
mf a[148:151],a[244:247],v[148:151],a[148:151]
mf a[152:155],a[244:247],v[152:155],a[152:155]
mf a[156:159],a[244:247],v[156:159],a[156:159]
s_waitcnt lgkmcnt(7)
mf a[128:131],a[248:251],v[160:163],a[128:131]
buffer_store_dwordx4 v[92:95], v7, s[28:31], s41 offen offset:3072 sc0 sc1
mf a[132:135],a[248:251],v[164:167],a[132:135]
mf a[136:139],a[248:251],v[168:171],a[136:139]
mf a[140:143],a[248:251],v[172:175],a[140:143]
mf a[144:147],a[248:251],v[176:179],a[144:147]
mf a[148:151],a[248:251],v[180:183],a[148:151]
mf a[152:155],a[248:251],v[184:187],a[152:155]
mf a[156:159],a[248:251],v[188:191],a[156:159]
s_waitcnt lgkmcnt(6)
mf a[128:131],a[252:255],v[208:211],a[128:131]
mf a[132:135],a[252:255],v[212:215],a[132:135]
mf a[136:139],a[252:255],v[216:219],a[136:139]
mf a[140:143],a[252:255],v[220:223],a[140:143]
mf a[144:147],a[252:255],v[224:227],a[144:147]
mf a[148:151],a[252:255],v[228:231],a[148:151]
mf a[152:155],a[252:255],v[232:235],a[152:155]
mf a[156:159],a[252:255],v[236:239],a[156:159]
s_waitcnt lgkmcnt(5)
mf a[128:131],a[216:219],v[32:35],a[128:131]
mf a[132:135],a[216:219],v[36:39],a[132:135]
mf a[136:139],a[216:219],v[40:43],a[136:139]
s_nop 5
ar v240,a128
ar v248,a129
mf a[140:143],a[216:219],v[44:47],a[140:143]
ar v241,a132
ar v249,a133
mf a[144:147],a[216:219],v[48:51],a[144:147]
ar v242,a136
ar v250,a137
mf a[148:151],a[216:219],v[52:55],a[148:151]
s_nop 1
ar v243,a140
ar v251,a141
mf a[152:155],a[216:219],v[56:59],a[152:155]
ar v244,a144
ar v252,a145
mf a[156:159],a[216:219],v[60:63],a[156:159]
ar v245,a148
ar v253,a149
mf a[160:163],a[212:215],v[16:19],a[160:163]
s_nop 1
ar v246,a152
ar v254,a153
mf a[164:167],a[212:215],v[20:23],a[164:167]
ar v247,a156
ar v255,a157
mf a[168:171],a[212:215],v[24:27],a[168:171]
cv v64,v240,v241
cv v65,v242,v243
mf a[172:175],a[212:215],v[28:31],a[172:175]
cv v66,v244,v245
cv v67,v246,v247
mf a[176:179],a[212:215],v[192:195],a[176:179]
buffer_store_dwordx4 v[64:67], v7, s[28:31], s48 offen sc0 sc1
cv v68,v248,v249
mf a[180:183],a[212:215],v[196:199],a[180:183]
cv v69,v250,v251
cv v70,v252,v253
mf a[184:187],a[212:215],v[200:203],a[184:187]
cv v71,v254,v255
ar v240,a130
mf a[188:191],a[212:215],v[204:207],a[188:191]
ar v241,a134
ar v242,a138
s_waitcnt lgkmcnt(4)
mf a[160:163],a[220:223],v[96:99],a[160:163]
ar v243,a142
ar v244,a146
mf a[164:167],a[220:223],v[100:103],a[164:167]
ar v245,a150
ar v246,a154
mf a[168:171],a[220:223],v[104:107],a[168:171]
ar v247,a158
buffer_store_dwordx4 v[68:71], v7, s[28:31], s48 offen offset:1024 sc0 sc1
mf a[172:175],a[220:223],v[108:111],a[172:175]
ar v248,a131
ar v249,a135
mf a[176:179],a[220:223],v[112:115],a[176:179]
ar v250,a139
ar v251,a143
mf a[180:183],a[220:223],v[116:119],a[180:183]
ar v252,a147
ar v253,a151
mf a[184:187],a[220:223],v[120:123],a[184:187]
ar v254,a155
ar v255,a159
mf a[188:191],a[220:223],v[124:127],a[188:191]
cv v72,v240,v241
cv v73,v242,v243
s_waitcnt lgkmcnt(3)
mf a[160:163],a[224:227],v[128:131],a[160:163]
cv v74,v244,v245
cv v75,v246,v247
mf a[164:167],a[224:227],v[132:135],a[164:167]
buffer_store_dwordx4 v[72:75], v7, s[28:31], s48 offen offset:2048 sc0 sc1
cv v76,v248,v249
mf a[168:171],a[224:227],v[136:139],a[168:171]
cv v77,v250,v251
cv v78,v252,v253
mf a[172:175],a[224:227],v[140:143],a[172:175]
cv v79,v254,v255
mf a[176:179],a[224:227],v[144:147],a[176:179]
mf a[180:183],a[224:227],v[148:151],a[180:183]
mf a[184:187],a[224:227],v[152:155],a[184:187]
mf a[188:191],a[224:227],v[156:159],a[188:191]
buffer_store_dwordx4 v[76:79], v7, s[28:31], s48 offen offset:3072 sc0 sc1
s_waitcnt lgkmcnt(2)
mf a[160:163],a[228:231],v[160:163],a[160:163]
mf a[164:167],a[228:231],v[164:167],a[164:167]
mf a[168:171],a[228:231],v[168:171],a[168:171]
mf a[172:175],a[228:231],v[172:175],a[172:175]
mf a[176:179],a[228:231],v[176:179],a[176:179]
mf a[180:183],a[228:231],v[180:183],a[180:183]
mf a[184:187],a[228:231],v[184:187],a[184:187]
mf a[188:191],a[228:231],v[188:191],a[188:191]
s_waitcnt lgkmcnt(1)
mf a[160:163],a[232:235],v[208:211],a[160:163]
mf a[164:167],a[232:235],v[212:215],a[164:167]
mf a[168:171],a[232:235],v[216:219],a[168:171]
mf a[172:175],a[232:235],v[220:223],a[172:175]
mf a[176:179],a[232:235],v[224:227],a[176:179]
mf a[180:183],a[232:235],v[228:231],a[180:183]
mf a[184:187],a[232:235],v[232:235],a[184:187]
mf a[188:191],a[232:235],v[236:239],a[188:191]
s_waitcnt lgkmcnt(0)
mf a[160:163],a[236:239],v[32:35],a[160:163]
mf a[164:167],a[236:239],v[36:39],a[164:167]
mf a[168:171],a[236:239],v[40:43],a[168:171]
s_nop 5
ar v240,a160
ar v248,a161
mf a[172:175],a[236:239],v[44:47],a[172:175]
ar v241,a164
ar v249,a165
mf a[176:179],a[236:239],v[48:51],a[176:179]
ar v242,a168
ar v250,a169
mf a[180:183],a[236:239],v[52:55],a[180:183]
s_nop 1
ar v243,a172
ar v251,a173
mf a[184:187],a[236:239],v[56:59],a[184:187]
ar v244,a176
ar v252,a177
mf a[188:191],a[236:239],v[60:63],a[188:191]
ar v245,a180
ar v253,a181
cv v80,v240,v241
cv v81,v242,v243
s_nop 0
ar v246,a184
ar v254,a185
cv v82,v244,v245
cv v84,v248,v249
ar v247,a188
ar v255,a189
cv v83,v246,v247
buffer_store_dwordx4 v[80:83], v7, s[28:31], s49 offen sc0 sc1
cv v85,v250,v251
cv v86,v252,v253
cv v87,v254,v255
ar v240,a162
ar v241,a166
ar v242,a170
ar v243,a174
ar v244,a178
ar v245,a182
ar v246,a186
ar v247,a190
ar v248,a163
ar v249,a167
ar v250,a171
ar v251,a175
ar v252,a179
ar v253,a183
ar v254,a187
ar v255,a191
cv v88,v240,v241
cv v89,v242,v243
cv v90,v244,v245
cv v91,v246,v247
cv v92,v248,v249
buffer_store_dwordx4 v[84:87], v7, s[28:31], s49 offen offset:1024 sc0 sc1
cv v93,v250,v251
cv v94,v252,v253
cv v95,v254,v255
buffer_store_dwordx4 v[88:91], v7, s[28:31], s49 offen offset:2048 sc0 sc1
buffer_store_dwordx4 v[92:95], v7, s[28:31], s49 offen offset:3072 sc0 sc1
L_end0:
s_endpgm
.globl head_reduce_kernel
.p2align 8
.type head_reduce_kernel,@function
head_reduce_kernel:
s_cmp_ge_u32 s2, 768
s_cbranch_scc1 L_k2_end
s_load_dwordx2 s[4:5], s[0:1], 96
s_load_dwordx2 s[8:9], s[0:1], 80
s_and_b32 s3, s2, 3
s_bfe_u32 s12, s2, 0x10002
s_lshr_b32 s13, s2, 3
s_lshl_b32 s13, s13, 2
s_add_u32 s3, s3, s13
s_mul_i32 s12, s12, 384
s_add_u32 s2, s3, s12
s_mul_i32 s3, s2, 2731
s_lshr_b32 s3, s3, 16
s_mul_i32 s12, s3, 24
s_sub_u32 s12, s2, s12
s_mul_i32 s12, s12, 256
v_add_u32 v0, s12, v0
v_lshlrev_b32 v1, 4, v0
v_lshrrev_b32 v2, 6, v0
v_and_b32 v3, 63, v0
v_lshlrev_b32 v3, 4, v3
v_lshl_add_u32 v2, v2, 11, v3
s_mul_i32 s13, s3, 786432
s_and_b32 s14, s3, 15
s_mul_i32 s14, s14, 196608
s_lshr_b32 s15, s3, 4
s_lshl_b32 s15, s15, 10
s_add_u32 s14, s14, s15
s_mov_b32 s16, 0
s_mov_b32 s17, 98304
s_mov_b32 s18, 196608
s_mov_b32 s19, 294912
s_mov_b32 s20, 393216
s_mov_b32 s21, 491520
s_mov_b32 s22, 589824
s_mov_b32 s23, 688128
s_mov_b32 s24, 0xffff0000
s_waitcnt lgkmcnt(0)
s_add_u32 s4, s4, s13
s_addc_u32 s5, s5, 0
s_and_b32 s5, s5, 0xffff
s_mov_b32 s6, 786432
s_mov_b32 s7, 0x20000
s_add_u32 s8, s8, s14
s_addc_u32 s9, s9, 0
s_and_b32 s9, s9, 0xffff
s_sub_u32 s10, 0x300000, s14
s_mov_b32 s11, 0x20000
buffer_load_dwordx4 v[4:7], v1, s[4:7], s16 offen
buffer_load_dwordx4 v[8:11], v1, s[4:7], s17 offen
buffer_load_dwordx4 v[12:15], v1, s[4:7], s18 offen
buffer_load_dwordx4 v[16:19], v1, s[4:7], s19 offen
buffer_load_dwordx4 v[20:23], v1, s[4:7], s20 offen
buffer_load_dwordx4 v[24:27], v1, s[4:7], s21 offen
buffer_load_dwordx4 v[28:31], v1, s[4:7], s22 offen
buffer_load_dwordx4 v[32:35], v1, s[4:7], s23 offen
s_waitcnt vmcnt(7)
v_lshlrev_b32 v36, 16, v4
v_and_b32 v37, s24, v4
v_lshlrev_b32 v38, 16, v5
v_and_b32 v39, s24, v5
v_lshlrev_b32 v40, 16, v6
v_and_b32 v41, s24, v6
v_lshlrev_b32 v42, 16, v7
v_and_b32 v43, s24, v7
s_waitcnt vmcnt(6)
v_lshlrev_b32 v44, 16, v8
v_and_b32 v45, s24, v8
v_add_f32 v36, v36, v44
v_add_f32 v37, v37, v45
v_lshlrev_b32 v44, 16, v9
v_and_b32 v45, s24, v9
v_add_f32 v38, v38, v44
v_add_f32 v39, v39, v45
v_lshlrev_b32 v44, 16, v10
v_and_b32 v45, s24, v10
v_add_f32 v40, v40, v44
v_add_f32 v41, v41, v45
v_lshlrev_b32 v44, 16, v11
v_and_b32 v45, s24, v11
v_add_f32 v42, v42, v44
v_add_f32 v43, v43, v45
s_waitcnt vmcnt(5)
v_lshlrev_b32 v44, 16, v12
v_and_b32 v45, s24, v12
v_add_f32 v36, v36, v44
v_add_f32 v37, v37, v45
v_lshlrev_b32 v44, 16, v13
v_and_b32 v45, s24, v13
v_add_f32 v38, v38, v44
v_add_f32 v39, v39, v45
v_lshlrev_b32 v44, 16, v14
v_and_b32 v45, s24, v14
v_add_f32 v40, v40, v44
v_add_f32 v41, v41, v45
v_lshlrev_b32 v44, 16, v15
v_and_b32 v45, s24, v15
v_add_f32 v42, v42, v44
v_add_f32 v43, v43, v45
s_waitcnt vmcnt(4)
v_lshlrev_b32 v44, 16, v16
v_and_b32 v45, s24, v16
v_add_f32 v36, v36, v44
v_add_f32 v37, v37, v45
v_lshlrev_b32 v44, 16, v17
v_and_b32 v45, s24, v17
v_add_f32 v38, v38, v44
v_add_f32 v39, v39, v45
v_lshlrev_b32 v44, 16, v18
v_and_b32 v45, s24, v18
v_add_f32 v40, v40, v44
v_add_f32 v41, v41, v45
v_lshlrev_b32 v44, 16, v19
v_and_b32 v45, s24, v19
v_add_f32 v42, v42, v44
v_add_f32 v43, v43, v45
s_waitcnt vmcnt(3)
v_lshlrev_b32 v44, 16, v20
v_and_b32 v45, s24, v20
v_add_f32 v36, v36, v44
v_add_f32 v37, v37, v45
v_lshlrev_b32 v44, 16, v21
v_and_b32 v45, s24, v21
v_add_f32 v38, v38, v44
v_add_f32 v39, v39, v45
v_lshlrev_b32 v44, 16, v22
v_and_b32 v45, s24, v22
v_add_f32 v40, v40, v44
v_add_f32 v41, v41, v45
v_lshlrev_b32 v44, 16, v23
v_and_b32 v45, s24, v23
v_add_f32 v42, v42, v44
v_add_f32 v43, v43, v45
s_waitcnt vmcnt(2)
v_lshlrev_b32 v44, 16, v24
v_and_b32 v45, s24, v24
v_add_f32 v36, v36, v44
v_add_f32 v37, v37, v45
v_lshlrev_b32 v44, 16, v25
v_and_b32 v45, s24, v25
v_add_f32 v38, v38, v44
v_add_f32 v39, v39, v45
v_lshlrev_b32 v44, 16, v26
v_and_b32 v45, s24, v26
v_add_f32 v40, v40, v44
v_add_f32 v41, v41, v45
v_lshlrev_b32 v44, 16, v27
v_and_b32 v45, s24, v27
v_add_f32 v42, v42, v44
v_add_f32 v43, v43, v45
s_waitcnt vmcnt(1)
v_lshlrev_b32 v44, 16, v28
v_and_b32 v45, s24, v28
v_add_f32 v36, v36, v44
v_add_f32 v37, v37, v45
v_lshlrev_b32 v44, 16, v29
v_and_b32 v45, s24, v29
v_add_f32 v38, v38, v44
v_add_f32 v39, v39, v45
v_lshlrev_b32 v44, 16, v30
v_and_b32 v45, s24, v30
v_add_f32 v40, v40, v44
v_add_f32 v41, v41, v45
v_lshlrev_b32 v44, 16, v31
v_and_b32 v45, s24, v31
v_add_f32 v42, v42, v44
v_add_f32 v43, v43, v45
s_waitcnt vmcnt(0)
v_lshlrev_b32 v44, 16, v32
v_and_b32 v45, s24, v32
v_add_f32 v36, v36, v44
v_add_f32 v37, v37, v45
v_lshlrev_b32 v44, 16, v33
v_and_b32 v45, s24, v33
v_add_f32 v38, v38, v44
v_add_f32 v39, v39, v45
v_lshlrev_b32 v44, 16, v34
v_and_b32 v45, s24, v34
v_add_f32 v40, v40, v44
v_add_f32 v41, v41, v45
v_lshlrev_b32 v44, 16, v35
v_and_b32 v45, s24, v35
v_add_f32 v42, v42, v44
v_add_f32 v43, v43, v45
cv v4,v36,v37
cv v5,v38,v39
cv v6,v40,v41
cv v7,v42,v43
buffer_store_dwordx4 v[4:7], v2, s[8:11], 0 offen
L_k2_end:
s_endpgm
.section .rodata,"a"
.p2align 6
.amdhsa_kernel concat_heads__mha_block_cached__gqa_block_cached__near_ridge_kernel
  .amdhsa_next_free_vgpr 512
  .amdhsa_next_free_sgpr 102
  .amdhsa_accum_offset 256
  .amdhsa_group_segment_fixed_size 0
  .amdhsa_kernarg_size 104
  .amdhsa_user_sgpr_count 2
  .amdhsa_user_sgpr_kernarg_segment_ptr 1
  .amdhsa_system_sgpr_workgroup_id_x 1
.end_amdhsa_kernel
.p2align 6
.amdhsa_kernel head_reduce_kernel
  .amdhsa_next_free_vgpr 48
  .amdhsa_next_free_sgpr 32
  .amdhsa_accum_offset 48
  .amdhsa_group_segment_fixed_size 0
  .amdhsa_kernarg_size 104
  .amdhsa_user_sgpr_count 2
  .amdhsa_user_sgpr_kernarg_segment_ptr 1
  .amdhsa_system_sgpr_workgroup_id_x 1
.end_amdhsa_kernel
```
